```python
import torch

def _softmax(x, axis=-1):
    return torch.softmax(x, dim=axis)
def _gelu(x):
    return torch.nn.functional.gelu(x, approximate="tanh")
def _silu(x):
    return torch.nn.functional.silu(x)
def _sigmoid(x):
    return torch.sigmoid(x)
def _layernorm(x, axis=-1, eps=1e-5):
    m = x.mean(dim=axis, keepdim=True)
    v = x.var(dim=axis, keepdim=True, unbiased=False)
    return (x - m) / torch.sqrt(v + eps)
def _scatter_add(tgt, idx, src, axis=0):
    return tgt.clone().index_add_(axis, idx, src)
def _segment_sum(src, seg, n):
    out = torch.zeros((n,) + src.shape[1:], dtype=src.dtype)
    return out.index_add_(0, seg, src)
def _pad(x, pw):
    flat = tuple(v for pair in reversed(pw) for v in pair)
    return torch.nn.functional.pad(x, flat)

kernel_name = 'gated_mix__ssm_conv_s4__geglu_ffn__prompt'

def setup_inputs():

    _w = (lambda a: (lambda t: t.to(torch.bfloat16) if t.is_floating_point() else t)(torch.as_tensor(a)))
    def _A_setup():
        B, L, D, N = 1, 2048, 448, 256
        A_re = -(lambda _x: torch.exp(torch.as_tensor(_x)))((lambda *s: torch.randn(*s, dtype=torch.bfloat16) * 3.2)(D, N))
        A_im = torch.pi * (lambda *s: torch.randn(*s, dtype=torch.bfloat16) * 0.05)(D, N)
        B_re = (lambda *s: torch.randn(*s, dtype=torch.bfloat16) * 0.05)(D, N)
        B_im = (lambda *s: torch.randn(*s, dtype=torch.bfloat16) * 0.05)(D, N)
        C_re = (lambda *s: torch.randn(*s, dtype=torch.bfloat16) * 0.1)(D, N)
        C_im = (lambda *s: torch.randn(*s, dtype=torch.bfloat16) * 0.1)(D, N)
        log_dt = (lambda *s: torch.randn(*s, dtype=torch.bfloat16) * 0.05)(D) * 0.5 - 4.0
        Dskip = (lambda *s: torch.randn(*s, dtype=torch.bfloat16) * 0.05)(D)
        return {
            "u": _w((lambda *s: torch.randn(*s, dtype=torch.bfloat16) * 0.05)(B, L, D)),
            "A_re": _w(A_re),
            "A_im": _w(A_im),
            "B_re": _w(B_re),
            "B_im": _w(B_im),
            "C_re": _w(C_re),
            "C_im": _w(C_im),
            "log_dt": _w(log_dt),
            "Dskip": _w(Dskip),
        }
    _A_in = _A_setup()

    def _B_setup():
        B, S, D, F = 1, 2048, 448, 1792
        return {
            "x": _w((lambda *s: torch.randn(*s, dtype=torch.bfloat16) * 0.05)(B, S, D)),
            "w_gate": _w((lambda *s: torch.randn(*s, dtype=torch.bfloat16) * 0.05)(D, F)),
            "w_up": _w((lambda *s: torch.randn(*s, dtype=torch.bfloat16) * 0.05)(D, F)),
            "w_down": _w((lambda *s: torch.randn(*s, dtype=torch.bfloat16) * 0.05)(F, D)),
        }
    _B_in = _B_setup()

    return {
        "A_u": _A_in["u"],
        "A_A_re": _A_in["A_re"],
        "A_A_im": _A_in["A_im"],
        "A_B_re": _A_in["B_re"],
        "A_B_im": _A_in["B_im"],
        "A_C_re": _A_in["C_re"],
        "A_C_im": _A_in["C_im"],
        "A_log_dt": _A_in["log_dt"],
        "A_Dskip": _A_in["Dskip"],
        "B_x": _B_in["x"],
        "B_w_gate": _B_in["w_gate"],
        "B_w_up": _B_in["w_up"],
        "B_w_down": _B_in["w_down"],
        "gate_w": _w((lambda *s: torch.randn(*s, dtype=torch.bfloat16) * 0.05)(448) * 16.0),
    }

def reference(A_u, A_A_re, A_A_im, A_B_re, A_B_im, A_C_re, A_C_im, A_log_dt, A_Dskip, B_x, B_w_gate, B_w_up, B_w_down, gate_w):
    def _A_ref(u, A_re, A_im, B_re, B_im, C_re, C_im, log_dt, Dskip):
        Bsz, L, D = u.shape
        dt = torch.exp(log_dt)[:, None]
        A = A_re + 1j * A_im
        Bc = B_re + 1j * B_im
        Cc = C_re + 1j * C_im
        logdA = dt * A
        dB = dt * Bc
        l = (lambda x, dt: x.to(dt))(torch.arange(L), A_re.dtype)
        P = torch.exp(logdA[:, :, None] * l[None, None, :])
        K = torch.einsum("dn,dnl,dn->dl", Cc, P, dB).real
        L2 = 2 * L
        Kp = _pad(K, ((0, 0), (0, L)))
        up = (lambda x, *d: x.permute(*d))(u, 0, 2, 1)
        up = _pad(up, ((0, 0), (0, 0), (0, L)))
        Kf = (lambda x, axes=(-2,-1): torch.fft.rfft2(x.float(), dim=axes))(Kp[:, None, :], axes=(-2, -1))
        Uf = (lambda x, axes=(-2,-1): torch.fft.rfft2(x.float(), dim=axes))(up[:, :, None, :], axes=(-2, -1))
        Yf = Uf * Kf[None, :, :, :]
        y = (lambda x, s, axes=(-2,-1): torch.fft.irfft2(x, s=s, dim=axes).to(torch.bfloat16))(Yf, (1, L2), axes=(-2, -1))[:, :, 0, :L]
        y = (lambda x, *d: x.permute(*d))(y, 0, 2, 1) + u * Dskip[None, None, :]
        return y

    def _B_ref(x, w_gate, w_up, w_down):
        return (_gelu(x @ w_gate) * (x @ w_up)) @ w_down

    x = A_u
    g = _sigmoid((x * gate_w).sum(-1, keepdims=True))
    a = _A_ref(x, A_A_re, A_A_im, A_B_re, A_B_im, A_C_re, A_C_im, A_log_dt, A_Dskip)
    b = _B_ref(x, B_w_gate, B_w_up, B_w_down)
    return g * a + (1 - g) * b
```

```asm
; @launch grid=(256,1,1) block=(256,1,1) lds=163840
.amdgcn_target "amdgcn-amd-amdhsa--gfx950"
.text
.p2align 12
.globl gated_mix__ssm_conv_s4__geglu_ffn__prompt_kernel
.p2align 8
.type gated_mix__ssm_conv_s4__geglu_ffn__prompt_kernel,@function
gated_mix__ssm_conv_s4__geglu_ffn__prompt_kernel:
    s_load_dwordx16 s[16:31], s[0:1], 0
    s_load_dwordx16 s[32:47], s[0:1], 64
    s_nop 0
    s_cmpk_ge_u32 s2, 256
    s_cbranch_scc1 L_end
    s_cmp_ge_u32 s2, 32
    s_cbranch_scc1 L_main
    s_getpc_b64 s[4:5]
    v_lshlrev_b32 v1, 7, v0
    v_min_u32 v1, L_last-L_main, v1
    global_load_dword v19, v1, s[4:5]
    s_branch L_helper
L_main:
    v_lshrrev_b32 v240, 6, v0
    s_sub_u32 s4, s2, 32
    v_bfe_u32 v244, v0, 3, 3
    v_readfirstlane_b32 s3, v240
    s_lshl_b32 s14, s4, 10
    v_lshl_add_u32 v83, v0, 2, s14
    v_and_b32 v241, 7, v0
    v_lshrrev_b32 v242, 1, v244
    v_mul_u32_u24 v244, 896, v244
    s_bfe_u32 s87, s4, 0x20003
    s_and_b32 s50, s4, 6
    s_lshl1_add_u32 s89, s50, s87
    v_xor_b32 v243, v241, v242
    s_lshl2_add_u32 s14, s89, s3
    s_mulk_i32 s14, 28672
    v_lshl_add_u32 v16, v243, 4, v244
    s_lshl_b32 s15, s50, 7
    s_add_u32 s5, s14, s15
    s_movk_i32 s15, 6144
    v_xad_u32 v17, v16, 64, s15
    s_add_u32 s9, s3, 12
    s_lshl_b32 s9, s9, 12
    s_lshl_b32 s15, s15, 1
    v_add_u32 v18, s15, v16
    v_add_u32_e64 v19, s15, v17
    s_mov_b32 s54, 1835008
    s_mov_b32 s55, 0x20000
    s_and_b32 s11, s3, 1
    s_lshr_b32 s13, s3, 1
    s_lshr_b32 s88, s4, 5
    s_and_b32 s90, s4, 1
    s_mulk_i32 s90, 7
    s_add_u32 s90, s90, s88
    s_lshl1_add_u32 s6, s50, s13
    s_mulk_i32 s6, 896
    s_add_u32 s6, s6, s90
    s_lshl_b32 s6, s6, 7
    s_lshl1_add_u32 s10, s11, s13
    s_add_u32 s10, s10, 12
    s_lshl_b32 s10, s10, 12
    v_and_b32 v242, 1, v242
    s_movk_i32 s15, 27648
    v_lshlrev_b32 v242, 1, v242
    v_xor_b32 v245, v241, v242
    v_lshl_add_u32 v245, v245, 2, v244
    v_lshlrev_b32 v8, 2, v245
    v_xad_u32 v9, v8, 64, s15
    s_lshl_b32 s15, s15, 1
    v_add_u32 v10, s15, v8
    v_add_u32 v11, s15, v9
    s_mov_b32 s58, 1605632
    s_mov_b32 s59, s55
L_karg:
    s_waitcnt lgkmcnt(0)
L_karg2:
    s_lshl_b32 s83, s4, 2
    s_load_dword s82, s[30:31], s83
    s_load_dword s83, s[32:33], s83
    s_load_dwordx2 s[48:49], s[0:1], 128
L_f1:
    global_load_dword v232, v83, s[18:19]
L_par0:
    global_load_dword v233, v83, s[20:21]
    global_load_dword v234, v83, s[22:23]
    global_load_dword v235, v83, s[24:25]
    global_load_dword v236, v83, s[26:27]
    global_load_dword v237, v83, s[28:29]
    s_mov_b64 s[52:53], s[16:17]
    s_cmp_eq_u32 s11, 1
    s_cselect_b64 s[56:57], s[38:39], s[36:37]
    s_add_u32 m0, s9, 0
    s_nop 0
    buffer_load_dwordx4 v16, s[52:55], s5 offen offset:0 lds
    buffer_load_dwordx4 v17, s[52:55], s5 offen offset:1024 lds
    buffer_load_dwordx4 v18, s[52:55], s5 offen offset:2048 lds
    s_nop 0
    buffer_load_dwordx4 v19, s[52:55], s5 offen offset:3072 lds
    s_add_u32 m0, s10, 16384
    s_nop 0
    buffer_load_dwordx4 v8, s[56:59], s6 offen offset:0 lds
    s_nop 0
    buffer_load_dwordx4 v9, s[56:59], s6 offen offset:1024 lds
    buffer_load_dwordx4 v10, s[56:59], s6 offen offset:2048 lds
    buffer_load_dwordx4 v11, s[56:59], s6 offen offset:3072 lds
L_hotend:
    s_add_u32 s97, s14, 896
    s_sub_u32 s15, 7, s50
    s_mul_i32 s15, s15, 229376
    s_add_u32 s98, s6, s15
    v_and_b32 v2, 63, v0
    s_and_b32 s85, s4, 7
    s_lshl2_add_u32 s91, s85, s87
    v_lshlrev_b32 v1, 4, v2
    s_add_u32 s85, s6, 1792
    s_add_u32 s87, s98, 1792
    s_add_u32 s5, s5, 128
    s_cmp_eq_u32 s5, s97
    s_nop 0
    s_cselect_b32 s96, 896, 0
    s_sub_u32 s5, s5, s96
    s_add_u32 s6, s6, 229376
    s_cmp_eq_u32 s6, s98
    s_cselect_b32 s96, 1605632, 0
    s_sub_u32 s6, s6, s96
    s_mul_i32 s84, s3, 4352
    s_mov_b32 s60, s40
    s_mov_b32 s61, s41
    s_mov_b32 s62, 1605632
    s_nop 0
    s_mov_b32 s63, 0x20000
    s_mov_b32 s68, s44
    s_mov_b32 s69, s45
    s_mov_b32 s70, 1835008
    s_mov_b32 s71, 0x20000
    v_mov_b32 v242, 0
    v_min_u32 v245, 39, v2
    v_and_b32 v240, 15, v2
    s_lshl_b32 s14, s13, 13
    v_lshlrev_b32_e64 v245, 2, v245
    s_add_u32 s14, s14, 49152
    v_lshl_add_u32 v240, v240, 7, s14
    v_bfe_u32 v246, v2, 1, 3
    v_lshrrev_b32 v247, 4, v2
    v_and_b32 v241, 3, v2
    v_bfe_u32 v244, v2, 3, 2
    v_xor_b32 v246, v246, v247
    s_lshl_b32 s14, s11, 1
    v_xor_b32_e64 v244, s14, v244
    v_lshl_add_u32 v20, v246, 4, v240
    v_bfe_u32 v240, v2, 2, 2
    s_mov_b32 s15, 49152
    v_xor_b32_e64 v21, 64, v20
    v_add_u32 v22, 0x10000, v20
    v_lshl_add_u32 v241, v241, 3, s15
    v_add_u32 v23, 0x10000, v21
    v_lshl_add_u32 v240, v247, 3, v240
    v_lshl_add_u32 v244, v244, 5, v241
    v_and_b32 v72, 15, v2
    v_lshrrev_b32 v73, 4, v2
    v_lshl_add_u32 v12, v240, 7, v244
    v_bfe_u32 v76, v2, 3, 1
    v_mul_u32_u24 v74, 544, v72
    v_xor_b32_e64 v13, 32, v12
    v_add_u32 v14, 0x10000, v12
    v_lshl_add_u32 v75, v73, 4, s84
    v_add_u32 v15, 0x10000, v13
    v_mul_u32_u24 v76, 13056, v76
    s_add_u32 s14, s84, 2048
    v_cmp_gt_u32_e64 vcc, 2, v73
    v_add3_u32 v42, v74, v75, v76
    v_lshl_add_u32 v74, v73, 7, v72
    v_lshl_add_u32 v77, v73, 9, s84
    s_mov_b32 s92, 0xc0135761
    v_lshl_add_u32 v82, v74, 2, s14
    v_max_u32 v74, 1, v73
    v_cndmask_b32 v77, v77, v75, vcc
    v_cmp_eq_u32 vcc, 3, v73
    v_sub_u32_e64 v74, 6, v74
    s_mov_b32 s93, 0xc0135761
    s_mov_b32 s94, 1.0
    ds_write_b32 v245, v242 offset:34816
    ds_write_b32 v245, v242 offset:39104
    v_lshlrev_b32 v76, v74, v72
    v_lshlrev_b32 v74, v74, 16
    s_mov_b32 s95, 1.0
    v_add_u32_e64 v43, v77, v76
    v_mov_b32 v76, 256
    v_mov_b32 v80, 0xbdd2d3e8
    v_add_u32 v45, v43, v74
    v_cndmask_b32 v76, 8, v76, vcc
    v_mov_b32 v81, 0xbdd2d3e8
    v_lshrrev_b32 v72, 3, v2
    v_add_u32 v44, v43, v76
    v_add_u32 v46, v45, v76
    v_and_b32 v73, 7, v2
    v_mul_u32_u24 v72, 57344, v72
    v_lshlrev_b32_e64 v33, 4, v0
    v_bfe_u32 v76, v2, 3, 2
    v_lshl_add_u32 v32, v73, 4, v72
    v_and_b32 v73, 3, v2
    s_lshl_b32 s14, s11, 1
    v_lshrrev_b32 v77, 2, v2
    v_xor_b32 v76, s14, v76
    v_lshl_add_u32 v78, v73, 3, s9
    s_lshl_b32 s14, s13, 11
    v_add_u32 v34, s14, v1
    v_lshl_add_u32 v78, v77, 7, v78
    v_and_b32_e64 v6, 15, v2
    v_xor_b32 v35, 0x800, v34
    v_lshl_add_u32 v24, v76, 5, v78
    v_lshlrev_b32 v6, 2, v6
    v_lshrrev_b32 v72, 3, v0
    v_xor_b32 v25, 32, v24
    v_xor_b32 v26, 64, v24
    v_xor_b32 v27, 96, v24
    v_add_u32 v28, 0x10000, v24
    v_add_u32 v29, 0x10000, v25
    v_add_u32 v30, 0x10000, v26
    v_add_u32 v31, 0x10000, v27
    v_and_b32 v73, 7, v0
    v_mul_u32_u24 v76, 272, v72
    v_cmp_ne_u32 s[16:17], 0, v72
    v_cmp_eq_u32 vcc, 0, v73
    v_lshl_add_u32 v39, v73, 5, v76
    v_mov_b32 v77, 34816
    s_and_b64 vcc, vcc, s[16:17]
    v_add_u32 v78, 8688, v76
    v_add_u32 v76, -16, v76
    v_bfe_u32 v72, v2, 2, 2
    v_cndmask_b32 v41, v77, v78, vcc
    v_cndmask_b32 v40, v77, v76, vcc
    v_and_b32 v73, 3, v2
    v_lshrrev_b32 v74, 4, v2
    s_mul_i32 s14, s13, 4224
    s_add_u32 s14, s14, 17408
    v_lshl_add_u32 v74, v74, 3, v72
    v_lshl_add_u32 v75, v73, 5, s14
    s_mul_i32 s14, s13, 4288
    v_lshlrev_b32 v74, 3, v74
    s_lshl_b32 s15, s11, 7
    s_add_u32 s14, s14, s15
    v_add_u32 v36, v75, v74
    s_add_u32 s14, s14, 35040
    v_lshl_add_u32 v79, v73, 3, s14
    s_mul_i32 s14, s13, 8704
    s_mul_i32 s15, s11, 272
    v_sub_u32 v37, v79, v74
    s_add_u32 s8, s14, s15
    s_add_u32 s14, s8, 0xffff9b00
    v_mov_b32 v76, 544
    v_add_u32 v78, 25856, v1
    v_cmp_lt_u32 vcc, 47, v2
    v_mad_u32_u24 v76, v76, v2, s14
    s_nop 0
    v_cndmask_b32 v38, v78, v76, vcc
    s_mov_b64 exec, 0
    s_cmp_eq_u32 s3, 0
    s_cbranch_scc1 L_st1
    s_cmp_eq_u32 s3, 1
    s_cbranch_scc1 L_st2
    s_cmp_eq_u32 s3, 2
    s_cbranch_scc1 L_st3
    s_branch L_st4
L_hopret:
    s_mov_b64 exec, -1
    s_lshl_b32 s15, s13, 4
    s_waitcnt lgkmcnt(0)
    s_lshr_b32 s15, s82, s15
    s_lshl_b32 s15, s15, 16
    v_mov_b32 v140, 0x3fb8aa3b
    v_mul_f32 v140, s15, v140
    v_exp_f32 v140, v140
    s_nop 0
    v_cvt_pk_bf16_f32 v140, 0, v140
    v_mov_b32 v141, v140
L_dtd:
    s_waitcnt vmcnt(13)
    v_lshlrev_b32 v128, 16, v232
    v_and_b32 v129, 0xffff0000, v232
    s_waitcnt vmcnt(12)
    v_lshlrev_b32 v130, 16, v233
    v_and_b32 v131, 0xffff0000, v233
    s_waitcnt vmcnt(11)
    v_lshlrev_b32 v132, 16, v234
    v_and_b32 v133, 0xffff0000, v234
    s_waitcnt vmcnt(10)
    v_lshlrev_b32 v134, 16, v235
    v_and_b32 v135, 0xffff0000, v235
    s_waitcnt vmcnt(9)
    v_lshlrev_b32 v136, 16, v236
    v_and_b32 v137, 0xffff0000, v236
    s_waitcnt vmcnt(8)
    v_lshlrev_b32 v138, 16, v237
    s_add_u32 m0, s9, 32768
    v_and_b32 v139, 0xffff0000, v237
    v_pk_mul_f32 v[128:129], v[128:129], v[140:141]
    v_pk_mul_f32 v[130:131], v[130:131], v[140:141]
    v_pk_mul_f32 v[132:133], v[132:133], v[140:141]
    v_pk_mul_f32 v[134:135], v[134:135], v[140:141]
    v_mul_f32 v144, 0x3fb8aa3b, v128
    v_mul_f32 v146, 0x3e22f983, v130
    v_mul_f32 v145, 0x3fb8aa3b, v129
    v_mul_f32 v147, 0x3e22f983, v131
    v_exp_f32 v144, v144
    v_fract_f32 v146, v146
    v_exp_f32 v145, v145
    v_fract_f32 v147, v147
    v_cos_f32 v156, v146
    v_sin_f32 v158, v146
    v_cos_f32 v157, v147
    v_sin_f32 v159, v147
    v_pk_mul_f32 v[156:157], v[156:157], v[144:145]
    v_mul_f32 v148, 0x43b8aa3b, v128
    v_pk_mul_f32 v[158:159], v[158:159], v[144:145]
    v_mul_f32 v150, 0x4222f983, v130
    v_mul_f32 v149, 0x43b8aa3b, v129
    v_mul_f32 v151, 0x4222f983, v131
    v_exp_f32 v148, v148
    v_fract_f32 v150, v150
    v_exp_f32 v149, v149
    v_fract_f32 v151, v151
    v_cos_f32 v160, v150
    v_sin_f32 v162, v150
    v_cos_f32 v161, v151
    v_sin_f32 v163, v151
    v_pk_mul_f32 v[160:161], v[160:161], v[148:149]
    v_mul_f32 v152, 0x4138aa3b, v128
    v_pk_mul_f32 v[162:163], v[162:163], v[148:149]
    v_mul_f32 v154, 0x3fa2f983, v130
    v_mul_f32 v153, 0x4138aa3b, v129
    v_mul_f32 v155, 0x3fa2f983, v131
    v_exp_f32 v152, v152
    v_fract_f32 v154, v154
    v_exp_f32 v153, v153
    v_fract_f32 v155, v155
    v_cos_f32 v176, v154
    v_sin_f32 v178, v154
    v_cos_f32 v177, v155
    v_sin_f32 v179, v155
    v_pk_mul_f32 v[176:177], v[176:177], v[152:153]
    v_pk_mul_f32 v[164:165], v[136:137], v[132:133]
    v_pk_mul_f32 v[178:179], v[178:179], v[152:153]
    v_pk_mul_f32 v[166:167], v[136:137], v[134:135]
    v_pk_fma_f32 v[164:165], v[138:139], v[134:135], v[164:165] neg_lo:[1,0,0] neg_hi:[1,0,0]
    v_pk_mul_f32 v[168:169], v[156:157], v[156:157]
    v_pk_fma_f32 v[166:167], v[138:139], v[132:133], v[166:167]
    v_pk_mul_f32 v[170:171], v[156:157], v[158:159]
    v_pk_fma_f32 v[168:169], v[158:159], v[158:159], v[168:169] neg_lo:[1,0,0] neg_hi:[1,0,0]
    v_pk_mul_f32 v[172:173], v[160:161], v[160:161]
    v_pk_fma_f32 v[170:171], v[158:159], v[156:157], v[170:171]
    v_pk_mul_f32 v[174:175], v[160:161], v[162:163]
    v_pk_fma_f32 v[172:173], v[162:163], v[162:163], v[172:173] neg_lo:[1,0,0] neg_hi:[1,0,0]
    v_pk_mul_f32 v[180:181], v[176:177], v[176:177]
    v_pk_fma_f32 v[174:175], v[162:163], v[160:161], v[174:175]
    v_pk_mul_f32 v[182:183], v[176:177], v[178:179]
    v_pk_fma_f32 v[180:181], v[178:179], v[178:179], v[180:181] neg_lo:[1,0,0] neg_hi:[1,0,0]
    v_cvt_pk_bf16_f32 v192, v164, v165
    v_pk_fma_f32 v[182:183], v[178:179], v[176:177], v[182:183]
    v_cvt_pk_bf16_f32 v193, -v166, -v167
    v_pk_mul_f32 v[144:145], v[164:165], v[156:157]
    v_pk_mul_f32 v[146:147], v[164:165], v[158:159]
    v_pk_mul_f32 v[148:149], v[164:165], v[168:169]
    v_pk_fma_f32 v[144:145], v[166:167], v[158:159], v[144:145] neg_lo:[1,0,0] neg_hi:[1,0,0]
    v_pk_fma_f32 v[146:147], v[166:167], v[156:157], v[146:147]
    v_pk_mul_f32 v[150:151], v[164:165], v[170:171]
    v_cvt_pk_bf16_f32 v194, v144, v145
    v_cvt_pk_bf16_f32 v195, -v146, -v147
    v_pk_fma_f32 v[148:149], v[166:167], v[170:171], v[148:149] neg_lo:[1,0,0] neg_hi:[1,0,0]
    v_pk_fma_f32 v[150:151], v[166:167], v[168:169], v[150:151]
    v_pk_mul_f32 v[156:157], v[144:145], v[168:169]
    v_cvt_pk_bf16_f32 v196, v148, v149
    v_cvt_pk_bf16_f32 v197, -v150, -v151
    v_pk_mul_f32 v[158:159], v[144:145], v[170:171]
    v_pk_fma_f32 v[156:157], v[146:147], v[170:171], v[156:157] neg_lo:[1,0,0] neg_hi:[1,0,0]
    v_pk_mul_f32 v[152:153], v[164:165], v[160:161]
    v_pk_fma_f32 v[158:159], v[146:147], v[168:169], v[158:159]
    v_cvt_pk_bf16_f32 v198, v156, v157
    v_pk_mul_f32 v[154:155], v[164:165], v[162:163]
    v_cvt_pk_bf16_f32 v199, -v158, -v159
    v_pk_fma_f32 v[152:153], v[166:167], v[162:163], v[152:153] neg_lo:[1,0,0] neg_hi:[1,0,0]
    v_pk_fma_f32 v[154:155], v[166:167], v[160:161], v[154:155]
    v_pk_mul_f32 v[144:145], v[148:149], v[160:161]
    v_cvt_pk_bf16_f32 v208, v152, v153
    v_cvt_pk_bf16_f32 v209, -v154, -v155
    v_pk_mul_f32 v[146:147], v[148:149], v[162:163]
    v_pk_fma_f32 v[144:145], v[150:151], v[162:163], v[144:145] neg_lo:[1,0,0] neg_hi:[1,0,0]
    v_pk_mul_f32 v[184:185], v[164:165], v[172:173]
    v_pk_fma_f32 v[146:147], v[150:151], v[160:161], v[146:147]
    v_cvt_pk_bf16_f32 v210, v144, v145
    v_pk_mul_f32 v[186:187], v[164:165], v[174:175]
    v_cvt_pk_bf16_f32 v211, -v146, -v147
    v_pk_fma_f32 v[184:185], v[166:167], v[174:175], v[184:185] neg_lo:[1,0,0] neg_hi:[1,0,0]
    v_pk_fma_f32 v[186:187], v[166:167], v[172:173], v[186:187]
    v_pk_mul_f32 v[188:189], v[152:153], v[172:173]
    v_cvt_pk_bf16_f32 v216, v184, v185
    v_cvt_pk_bf16_f32 v217, -v186, -v187
    v_pk_mul_f32 v[190:191], v[152:153], v[174:175]
    v_pk_fma_f32 v[188:189], v[154:155], v[174:175], v[188:189] neg_lo:[1,0,0] neg_hi:[1,0,0]
    v_pk_mul_f32 v[164:165], v[148:149], v[168:169]
    v_pk_fma_f32 v[190:191], v[154:155], v[172:173], v[190:191]
    v_cvt_pk_bf16_f32 v220, v188, v189
    v_pk_mul_f32 v[166:167], v[148:149], v[170:171]
    v_cvt_pk_bf16_f32 v221, -v190, -v191
    v_pk_fma_f32 v[164:165], v[150:151], v[170:171], v[164:165] neg_lo:[1,0,0] neg_hi:[1,0,0]
    v_pk_fma_f32 v[166:167], v[150:151], v[168:169], v[166:167]
    v_pk_mul_f32 v[144:145], v[156:157], v[168:169]
    v_cvt_pk_bf16_f32 v200, v164, v165
    v_cvt_pk_bf16_f32 v201, -v166, -v167
    v_pk_mul_f32 v[146:147], v[156:157], v[170:171]
    v_pk_fma_f32 v[144:145], v[158:159], v[170:171], v[144:145] neg_lo:[1,0,0] neg_hi:[1,0,0]
    v_pk_mul_f32 v[148:149], v[164:165], v[168:169]
    v_pk_fma_f32 v[146:147], v[158:159], v[168:169], v[146:147]
    v_cvt_pk_bf16_f32 v202, v144, v145
    v_pk_mul_f32 v[150:151], v[164:165], v[170:171]
    v_cvt_pk_bf16_f32 v203, -v146, -v147
    v_pk_fma_f32 v[148:149], v[166:167], v[170:171], v[148:149] neg_lo:[1,0,0] neg_hi:[1,0,0]
    v_pk_fma_f32 v[150:151], v[166:167], v[168:169], v[150:151]
    v_pk_mul_f32 v[156:157], v[144:145], v[168:169]
    v_cvt_pk_bf16_f32 v204, v148, v149
    v_cvt_pk_bf16_f32 v205, -v150, -v151
    v_pk_mul_f32 v[158:159], v[144:145], v[170:171]
    v_pk_fma_f32 v[156:157], v[146:147], v[170:171], v[156:157] neg_lo:[1,0,0] neg_hi:[1,0,0]
    v_pk_mul_f32 v[152:153], v[164:165], v[160:161]
    v_pk_fma_f32 v[158:159], v[146:147], v[168:169], v[158:159]
    v_cvt_pk_bf16_f32 v206, v156, v157
    v_pk_mul_f32 v[154:155], v[164:165], v[162:163]
    v_cvt_pk_bf16_f32 v207, -v158, -v159
    v_pk_fma_f32 v[152:153], v[166:167], v[162:163], v[152:153] neg_lo:[1,0,0] neg_hi:[1,0,0]
    v_pk_fma_f32 v[154:155], v[166:167], v[160:161], v[154:155]
    v_pk_mul_f32 v[144:145], v[148:149], v[160:161]
    v_cvt_pk_bf16_f32 v212, v152, v153
    v_cvt_pk_bf16_f32 v213, -v154, -v155
    v_pk_mul_f32 v[146:147], v[148:149], v[162:163]
    v_pk_fma_f32 v[144:145], v[150:151], v[162:163], v[144:145] neg_lo:[1,0,0] neg_hi:[1,0,0]
    v_pk_mul_f32 v[156:157], v[164:165], v[172:173]
    v_pk_fma_f32 v[146:147], v[150:151], v[160:161], v[146:147]
    v_cvt_pk_bf16_f32 v214, v144, v145
    v_pk_mul_f32 v[158:159], v[164:165], v[174:175]
    v_cvt_pk_bf16_f32 v215, -v146, -v147
    v_pk_fma_f32 v[156:157], v[166:167], v[174:175], v[156:157] neg_lo:[1,0,0] neg_hi:[1,0,0]
    v_pk_fma_f32 v[158:159], v[166:167], v[172:173], v[158:159]
    v_pk_mul_f32 v[148:149], v[152:153], v[172:173]
    v_cvt_pk_bf16_f32 v218, v156, v157
    v_cvt_pk_bf16_f32 v219, -v158, -v159
    v_pk_mul_f32 v[150:151], v[152:153], v[174:175]
    v_pk_fma_f32 v[148:149], v[154:155], v[174:175], v[148:149] neg_lo:[1,0,0] neg_hi:[1,0,0]
    v_pk_mul_f32 v[144:145], v[184:185], v[172:173]
    v_pk_fma_f32 v[150:151], v[154:155], v[172:173], v[150:151]
    v_cvt_pk_bf16_f32 v222, v148, v149
    v_pk_mul_f32 v[146:147], v[184:185], v[174:175]
    v_cvt_pk_bf16_f32 v223, -v150, -v151
    v_pk_fma_f32 v[144:145], v[186:187], v[174:175], v[144:145] neg_lo:[1,0,0] neg_hi:[1,0,0]
    v_pk_fma_f32 v[146:147], v[186:187], v[172:173], v[146:147]
    v_pk_mul_f32 v[152:153], v[188:189], v[172:173]
    v_cvt_pk_bf16_f32 v118, v144, v145
    v_cvt_pk_bf16_f32 v119, -v146, -v147
    v_pk_mul_f32 v[154:155], v[188:189], v[174:175]
    v_pk_fma_f32 v[152:153], v[190:191], v[174:175], v[152:153] neg_lo:[1,0,0] neg_hi:[1,0,0]
    v_pk_mul_f32 v[184:185], v[144:145], v[172:173]
    v_pk_fma_f32 v[154:155], v[190:191], v[172:173], v[154:155]
    v_cvt_pk_bf16_f32 v120, v152, v153
    v_pk_mul_f32 v[186:187], v[144:145], v[174:175]
    v_cvt_pk_bf16_f32 v121, -v154, -v155
    v_pk_fma_f32 v[184:185], v[146:147], v[174:175], v[184:185] neg_lo:[1,0,0] neg_hi:[1,0,0]
    v_pk_fma_f32 v[186:187], v[146:147], v[172:173], v[186:187]
    v_pk_mul_f32 v[188:189], v[152:153], v[172:173]
    v_cvt_pk_bf16_f32 v122, v184, v185
    v_cvt_pk_bf16_f32 v123, -v186, -v187
    v_pk_mul_f32 v[190:191], v[152:153], v[174:175]
    v_pk_fma_f32 v[188:189], v[154:155], v[174:175], v[188:189] neg_lo:[1,0,0] neg_hi:[1,0,0]
    v_pk_mul_f32 v[144:145], v[184:185], v[172:173]
    v_pk_fma_f32 v[190:191], v[154:155], v[172:173], v[190:191]
    v_cvt_pk_bf16_f32 v124, v188, v189
    v_pk_mul_f32 v[146:147], v[184:185], v[174:175]
    v_cvt_pk_bf16_f32 v125, -v190, -v191
    v_pk_fma_f32 v[144:145], v[186:187], v[174:175], v[144:145] neg_lo:[1,0,0] neg_hi:[1,0,0]
    v_pk_fma_f32 v[146:147], v[186:187], v[172:173], v[146:147]
    v_cvt_pk_bf16_f32 v126, v144, v145
    v_cvt_pk_bf16_f32 v127, -v146, -v147
    buffer_load_dwordx4 v16, s[52:55], s5 offen offset:0 lds
    buffer_load_dwordx4 v17, s[52:55], s5 offen offset:1024 lds
    buffer_load_dwordx4 v18, s[52:55], s5 offen offset:2048 lds
    buffer_load_dwordx4 v19, s[52:55], s5 offen offset:3072 lds
    s_add_u32 s5, s5, 128
    s_cmp_eq_u32 s5, s97
    s_cselect_b32 s96, 896, 0
    s_sub_u32 s5, s5, s96
    s_add_u32 m0, s10, 49152
    s_nop 0
    s_nop 0
    buffer_load_dwordx4 v8, s[56:59], s6 offen offset:0 lds
    buffer_load_dwordx4 v9, s[56:59], s6 offen offset:1024 lds
    buffer_load_dwordx4 v10, s[56:59], s6 offen offset:2048 lds
    buffer_load_dwordx4 v11, s[56:59], s6 offen offset:3072 lds
    s_add_u32 s6, s6, 229376
    s_cmp_eq_u32 s6, s98
    s_cselect_b32 s96, 1605632, 0
    s_sub_u32 s6, s6, s96
    s_mov_b32 m0, s84
    s_nop 0
    ds_write_addtid_b32 v192 offset:0
    ds_write_addtid_b32 v193 offset:256
    ds_write_addtid_b32 v194 offset:544
    ds_write_addtid_b32 v195 offset:800
    ds_write_addtid_b32 v196 offset:1088
    ds_write_addtid_b32 v197 offset:1344
    ds_write_addtid_b32 v198 offset:1632
    ds_write_addtid_b32 v199 offset:1888
    ds_write_addtid_b32 v200 offset:2176
    ds_write_addtid_b32 v201 offset:2432
    ds_write_addtid_b32 v202 offset:2720
    ds_write_addtid_b32 v203 offset:2976
    ds_write_addtid_b32 v204 offset:3264
    ds_write_addtid_b32 v205 offset:3520
    ds_write_addtid_b32 v206 offset:3808
    ds_write_addtid_b32 v207 offset:4064
    ds_write_addtid_b32 v208 offset:17408
    ds_write_addtid_b32 v209 offset:17664
    ds_write_addtid_b32 v210 offset:17952
    ds_write_addtid_b32 v211 offset:18208
    ds_write_addtid_b32 v212 offset:18496
    ds_write_addtid_b32 v213 offset:18752
    ds_write_addtid_b32 v214 offset:19040
    ds_write_addtid_b32 v215 offset:19296
    ds_write_addtid_b32 v216 offset:19584
    ds_write_addtid_b32 v217 offset:19840
    ds_write_addtid_b32 v218 offset:20128
    ds_write_addtid_b32 v219 offset:20384
    ds_write_addtid_b32 v220 offset:20672
L_st1:
    s_cbranch_execz L_st5
    ds_write_addtid_b32 v221 offset:20928
    ds_write_addtid_b32 v222 offset:21216
    s_nop 0
    ds_write_addtid_b32 v223 offset:21472
    s_add_u32 m0, s9, 65536
    s_nop 0
    buffer_load_dwordx4 v16, s[52:55], s5 offen offset:0 lds
    s_nop 0
    v_mov_b32 v86, 0x3f803f80
    v_mov_b32_e64 v87, 0
    v_cvt_pk_bf16_f32 v88, v176, v177
    v_cvt_pk_bf16_f32 v89, v178, v179
    v_cvt_pk_bf16_f32 v90, v180, v181
    v_cvt_pk_bf16_f32 v91, v182, v183
    v_pk_mul_f32 v[204:205], v[176:177], v[180:181]
    v_pk_mul_f32 v[206:207], v[176:177], v[182:183]
    v_pk_mul_f32 v[192:193], v[180:181], v[180:181]
    v_pk_fma_f32 v[204:205], v[178:179], v[182:183], v[204:205] neg_lo:[1,0,0] neg_hi:[1,0,0]
    v_pk_fma_f32 v[206:207], v[178:179], v[180:181], v[206:207]
    v_pk_mul_f32 v[194:195], v[180:181], v[182:183]
    v_cvt_pk_bf16_f32 v92, v204, v205
    v_cvt_pk_bf16_f32 v93, v206, v207
    v_pk_fma_f32 v[192:193], v[182:183], v[182:183], v[192:193] neg_lo:[1,0,0] neg_hi:[1,0,0]
    v_pk_fma_f32 v[194:195], v[182:183], v[180:181], v[194:195]
    v_pk_mul_f32 v[196:197], v[204:205], v[180:181]
    v_cvt_pk_bf16_f32 v94, v192, v193
    v_cvt_pk_bf16_f32 v95, v194, v195
    v_pk_mul_f32 v[198:199], v[204:205], v[182:183]
    v_pk_fma_f32 v[196:197], v[206:207], v[182:183], v[196:197] neg_lo:[1,0,0] neg_hi:[1,0,0]
    v_pk_mul_f32 v[200:201], v[192:193], v[180:181]
    v_pk_fma_f32 v[198:199], v[206:207], v[180:181], v[198:199]
    v_cvt_pk_bf16_f32 v96, v196, v197
    v_pk_mul_f32 v[202:203], v[192:193], v[182:183]
    v_cvt_pk_bf16_f32 v97, v198, v199
    v_pk_fma_f32 v[200:201], v[194:195], v[182:183], v[200:201] neg_lo:[1,0,0] neg_hi:[1,0,0]
    v_pk_fma_f32 v[202:203], v[194:195], v[180:181], v[202:203]
    v_pk_mul_f32 v[204:205], v[196:197], v[180:181]
    v_cvt_pk_bf16_f32 v98, v200, v201
    v_cvt_pk_bf16_f32 v99, v202, v203
    v_pk_mul_f32 v[206:207], v[196:197], v[182:183]
    v_pk_fma_f32 v[204:205], v[198:199], v[182:183], v[204:205] neg_lo:[1,0,0] neg_hi:[1,0,0]
    v_pk_mul_f32 v[192:193], v[200:201], v[180:181]
    v_pk_fma_f32 v[206:207], v[198:199], v[180:181], v[206:207]
    v_cvt_pk_bf16_f32 v100, v204, v205
    v_pk_mul_f32 v[194:195], v[200:201], v[182:183]
    v_cvt_pk_bf16_f32 v101, v206, v207
    v_pk_fma_f32 v[192:193], v[202:203], v[182:183], v[192:193] neg_lo:[1,0,0] neg_hi:[1,0,0]
    v_pk_fma_f32 v[194:195], v[202:203], v[180:181], v[194:195]
    v_pk_mul_f32 v[196:197], v[204:205], v[180:181]
    v_cvt_pk_bf16_f32 v102, v192, v193
    v_cvt_pk_bf16_f32 v103, v194, v195
    v_pk_mul_f32 v[198:199], v[204:205], v[182:183]
    v_pk_fma_f32 v[196:197], v[206:207], v[182:183], v[196:197] neg_lo:[1,0,0] neg_hi:[1,0,0]
    v_pk_mul_f32 v[200:201], v[192:193], v[180:181]
    v_pk_fma_f32 v[198:199], v[206:207], v[180:181], v[198:199]
    v_cvt_pk_bf16_f32 v104, v196, v197
    v_pk_mul_f32 v[202:203], v[192:193], v[182:183]
    v_cvt_pk_bf16_f32 v105, v198, v199
    v_pk_fma_f32 v[200:201], v[194:195], v[182:183], v[200:201] neg_lo:[1,0,0] neg_hi:[1,0,0]
    v_pk_fma_f32 v[202:203], v[194:195], v[180:181], v[202:203]
    v_pk_mul_f32 v[204:205], v[196:197], v[180:181]
    v_cvt_pk_bf16_f32 v106, v200, v201
    v_cvt_pk_bf16_f32 v107, v202, v203
    v_pk_mul_f32 v[206:207], v[196:197], v[182:183]
    v_pk_fma_f32 v[204:205], v[198:199], v[182:183], v[204:205] neg_lo:[1,0,0] neg_hi:[1,0,0]
    v_pk_mul_f32 v[192:193], v[200:201], v[180:181]
    v_pk_fma_f32 v[206:207], v[198:199], v[180:181], v[206:207]
    v_cvt_pk_bf16_f32 v108, v204, v205
    v_pk_mul_f32 v[194:195], v[200:201], v[182:183]
    v_cvt_pk_bf16_f32 v109, v206, v207
    v_pk_fma_f32 v[192:193], v[202:203], v[182:183], v[192:193] neg_lo:[1,0,0] neg_hi:[1,0,0]
    v_pk_fma_f32 v[194:195], v[202:203], v[180:181], v[194:195]
    v_pk_mul_f32 v[196:197], v[204:205], v[180:181]
    v_cvt_pk_bf16_f32 v110, v192, v193
    v_cvt_pk_bf16_f32 v111, v194, v195
    v_pk_mul_f32 v[198:199], v[204:205], v[182:183]
    v_pk_fma_f32 v[196:197], v[206:207], v[182:183], v[196:197] neg_lo:[1,0,0] neg_hi:[1,0,0]
    v_pk_mul_f32 v[200:201], v[192:193], v[180:181]
    v_pk_fma_f32 v[198:199], v[206:207], v[180:181], v[198:199]
    v_cvt_pk_bf16_f32 v112, v196, v197
    v_pk_mul_f32 v[202:203], v[192:193], v[182:183]
    v_cvt_pk_bf16_f32 v113, v198, v199
    v_pk_fma_f32 v[200:201], v[194:195], v[182:183], v[200:201] neg_lo:[1,0,0] neg_hi:[1,0,0]
    v_pk_fma_f32 v[202:203], v[194:195], v[180:181], v[202:203]
    v_pk_mul_f32 v[204:205], v[196:197], v[180:181]
    v_cvt_pk_bf16_f32 v114, v200, v201
    v_cvt_pk_bf16_f32 v115, v202, v203
    v_pk_mul_f32 v[206:207], v[196:197], v[182:183]
    v_pk_fma_f32 v[204:205], v[198:199], v[182:183], v[204:205] neg_lo:[1,0,0] neg_hi:[1,0,0]
    v_pk_mul_f32 v[192:193], v[200:201], v[180:181]
    v_pk_fma_f32 v[206:207], v[198:199], v[180:181], v[206:207]
    v_cvt_pk_bf16_f32 v116, v204, v205
    v_pk_mul_f32 v[194:195], v[200:201], v[182:183]
    v_cvt_pk_bf16_f32 v117, v206, v207
    v_pk_fma_f32 v[192:193], v[202:203], v[182:183], v[192:193] neg_lo:[1,0,0] neg_hi:[1,0,0]
    v_pk_fma_f32 v[194:195], v[202:203], v[180:181], v[194:195]
    v_pk_mul_f32 v[196:197], v[204:205], v[180:181]
    v_cvt_pk_bf16_f32 v224, v192, v193
    v_cvt_pk_bf16_f32 v225, v194, v195
    v_pk_mul_f32 v[198:199], v[204:205], v[182:183]
    v_pk_fma_f32 v[196:197], v[206:207], v[182:183], v[196:197] neg_lo:[1,0,0] neg_hi:[1,0,0]
    v_pk_mul_f32 v[200:201], v[192:193], v[180:181]
    v_pk_fma_f32 v[198:199], v[206:207], v[180:181], v[198:199]
    v_cvt_pk_bf16_f32 v226, v196, v197
    v_pk_mul_f32 v[202:203], v[192:193], v[182:183]
    v_cvt_pk_bf16_f32 v227, v198, v199
    v_pk_fma_f32 v[200:201], v[194:195], v[182:183], v[200:201] neg_lo:[1,0,0] neg_hi:[1,0,0]
    v_pk_fma_f32 v[202:203], v[194:195], v[180:181], v[202:203]
    v_pk_mul_f32 v[204:205], v[196:197], v[180:181]
    v_cvt_pk_bf16_f32 v228, v200, v201
    v_cvt_pk_bf16_f32 v229, v202, v203
    v_pk_mul_f32 v[206:207], v[196:197], v[182:183]
    v_pk_fma_f32 v[204:205], v[198:199], v[182:183], v[204:205] neg_lo:[1,0,0] neg_hi:[1,0,0]
    v_pk_mul_f32 v[192:193], v[200:201], v[180:181]
    v_pk_fma_f32 v[206:207], v[198:199], v[180:181], v[206:207]
    v_cvt_pk_bf16_f32 v230, v204, v205
    v_pk_mul_f32 v[194:195], v[200:201], v[182:183]
    v_cvt_pk_bf16_f32 v231, v206, v207
    v_pk_fma_f32 v[192:193], v[202:203], v[182:183], v[192:193] neg_lo:[1,0,0] neg_hi:[1,0,0]
    v_pk_fma_f32 v[194:195], v[202:203], v[180:181], v[194:195]
    v_pk_mul_f32 v[196:197], v[204:205], v[180:181]
    v_cvt_pk_bf16_f32 v232, v192, v193
    v_cvt_pk_bf16_f32 v233, v194, v195
    v_pk_mul_f32 v[198:199], v[204:205], v[182:183]
    v_pk_fma_f32 v[196:197], v[206:207], v[182:183], v[196:197] neg_lo:[1,0,0] neg_hi:[1,0,0]
    v_pk_mul_f32 v[200:201], v[192:193], v[180:181]
    v_pk_fma_f32 v[198:199], v[206:207], v[180:181], v[198:199]
    v_cvt_pk_bf16_f32 v234, v196, v197
    v_pk_mul_f32 v[202:203], v[192:193], v[182:183]
    v_cvt_pk_bf16_f32 v235, v198, v199
    v_pk_fma_f32 v[200:201], v[194:195], v[182:183], v[200:201] neg_lo:[1,0,0] neg_hi:[1,0,0]
    v_pk_fma_f32 v[202:203], v[194:195], v[180:181], v[202:203]
    v_pk_mul_f32 v[204:205], v[196:197], v[180:181]
    v_cvt_pk_bf16_f32 v236, v200, v201
    v_cvt_pk_bf16_f32 v237, v202, v203
    v_pk_mul_f32 v[206:207], v[196:197], v[182:183]
    v_pk_fma_f32 v[204:205], v[198:199], v[182:183], v[204:205] neg_lo:[1,0,0] neg_hi:[1,0,0]
    v_pk_mul_f32 v[192:193], v[200:201], v[180:181]
    v_pk_fma_f32 v[206:207], v[198:199], v[180:181], v[206:207]
    v_cvt_pk_bf16_f32 v238, v204, v205
    v_pk_mul_f32 v[194:195], v[200:201], v[182:183]
    v_cvt_pk_bf16_f32 v239, v206, v207
    v_pk_fma_f32 v[192:193], v[202:203], v[182:183], v[192:193] neg_lo:[1,0,0] neg_hi:[1,0,0]
    v_pk_fma_f32 v[194:195], v[202:203], v[180:181], v[194:195]
    v_pk_mul_f32 v[196:197], v[204:205], v[180:181]
    v_cvt_pk_bf16_f32 v240, v192, v193
    v_cvt_pk_bf16_f32 v241, v194, v195
    v_pk_mul_f32 v[198:199], v[204:205], v[182:183]
    v_pk_fma_f32 v[196:197], v[206:207], v[182:183], v[196:197] neg_lo:[1,0,0] neg_hi:[1,0,0]
    v_pk_mul_f32 v[200:201], v[192:193], v[180:181]
    v_pk_fma_f32 v[198:199], v[206:207], v[180:181], v[198:199]
    v_cvt_pk_bf16_f32 v242, v196, v197
    v_pk_mul_f32 v[202:203], v[192:193], v[182:183]
    v_cvt_pk_bf16_f32 v243, v198, v199
    v_pk_fma_f32 v[200:201], v[194:195], v[182:183], v[200:201] neg_lo:[1,0,0] neg_hi:[1,0,0]
    v_pk_fma_f32 v[202:203], v[194:195], v[180:181], v[202:203]
    v_pk_mul_f32 v[204:205], v[196:197], v[180:181]
    v_cvt_pk_bf16_f32 v244, v200, v201
    v_cvt_pk_bf16_f32 v245, v202, v203
    v_pk_mul_f32 v[206:207], v[196:197], v[182:183]
    v_pk_fma_f32 v[204:205], v[198:199], v[182:183], v[204:205] neg_lo:[1,0,0] neg_hi:[1,0,0]
    v_pk_mul_f32 v[192:193], v[200:201], v[180:181]
    v_pk_fma_f32 v[206:207], v[198:199], v[180:181], v[206:207]
    v_cvt_pk_bf16_f32 v246, v204, v205
    v_pk_mul_f32 v[194:195], v[200:201], v[182:183]
    v_cvt_pk_bf16_f32 v247, v206, v207
    v_pk_fma_f32 v[192:193], v[202:203], v[182:183], v[192:193] neg_lo:[1,0,0] neg_hi:[1,0,0]
    v_pk_fma_f32 v[194:195], v[202:203], v[180:181], v[194:195]
    v_cvt_pk_bf16_f32 v248, v192, v193
    v_cvt_pk_bf16_f32 v249, v194, v195
    v_pk_mul_f32 v[196:197], v[204:205], v[180:181]
    v_pk_mul_f32 v[198:199], v[204:205], v[182:183]
    v_pk_fma_f32 v[196:197], v[206:207], v[182:183], v[196:197] neg_lo:[1,0,0] neg_hi:[1,0,0]
    v_pk_fma_f32 v[198:199], v[206:207], v[180:181], v[198:199]
    v_cvt_pk_bf16_f32 v250, v196, v197
    v_cvt_pk_bf16_f32 v251, v198, v199
    v_pk_mul_f32 v[200:201], v[192:193], v[180:181]
    v_pk_mul_f32 v[202:203], v[192:193], v[182:183]
    v_pk_fma_f32 v[200:201], v[194:195], v[182:183], v[200:201] neg_lo:[1,0,0] neg_hi:[1,0,0]
    v_pk_fma_f32 v[202:203], v[194:195], v[180:181], v[202:203]
    v_cvt_pk_bf16_f32 v252, v200, v201
    v_cvt_pk_bf16_f32 v253, v202, v203
    v_pk_mul_f32 v[204:205], v[196:197], v[180:181]
    v_pk_mul_f32 v[206:207], v[196:197], v[182:183]
    v_pk_fma_f32 v[204:205], v[198:199], v[182:183], v[204:205] neg_lo:[1,0,0] neg_hi:[1,0,0]
    v_pk_fma_f32 v[206:207], v[198:199], v[180:181], v[206:207]
    v_cvt_pk_bf16_f32 v254, v204, v205
    v_cvt_pk_bf16_f32 v255, v206, v207
    buffer_load_dwordx4 v17, s[52:55], s5 offen offset:1024 lds
    buffer_load_dwordx4 v18, s[52:55], s5 offen offset:2048 lds
    buffer_load_dwordx4 v19, s[52:55], s5 offen offset:3072 lds
    s_add_u32 s5, s5, 128
    s_cmp_eq_u32 s5, s97
    s_cselect_b32 s96, 896, 0
    s_sub_u32 s5, s5, s96
    s_add_u32 m0, s10, 81920
    s_nop 0
    s_nop 0
    buffer_load_dwordx4 v8, s[56:59], s6 offen offset:0 lds
    s_waitcnt vmcnt(13)
    s_barrier
    ds_read_b64_tr_b16 v[48:49], v12 offset:16384
    ds_read_b64_tr_b16 v[50:51], v12 offset:16896
    ds_read_b128 a[0:3], v20 offset:0
    ds_read_b128 a[4:7], v20 offset:2048
    ds_read_b128 a[8:11], v20 offset:4096
    buffer_load_dwordx4 v9, s[56:59], s6 offen offset:1024 lds
    ds_read_b128 a[12:15], v20 offset:6144
    ds_read_b64_tr_b16 v[52:53], v13 offset:16384
    ds_read_b64_tr_b16 v[54:55], v13 offset:16896
    ds_read_b64_tr_b16 v[56:57], v12 offset:24576
    ds_read_b64_tr_b16 v[58:59], v12 offset:25088
    ds_read_b64_tr_b16 v[60:61], v13 offset:24576
    ds_read_b64_tr_b16 v[62:63], v13 offset:25088
    buffer_load_dwordx4 v10, s[56:59], s6 offen offset:2048 lds
    buffer_load_dwordx4 v11, s[56:59], s6 offen offset:3072 lds
    s_add_u32 s6, s6, 229376
    s_cmp_eq_u32 s6, s98
    s_cselect_b32 s96, 1605632, 0
    s_sub_u32 s6, s6, s96
    s_waitcnt lgkmcnt(9)
    v_mfma_f32_16x16x32_bf16 v[128:131], v[48:51], a[0:3], 0
    s_lshl1_add_u32 s0, s89, s13
    ds_read_b64_tr_b16 v[64:65], v12 offset:20480
    s_waitcnt lgkmcnt(9)
    v_mfma_f32_16x16x32_bf16 v[144:147], v[48:51], a[4:7], 0
    s_lshl1_add_u32 s1, s90, s11
    ds_read_b64_tr_b16 v[66:67], v12 offset:20992
    s_waitcnt lgkmcnt(9)
    v_mfma_f32_16x16x32_bf16 v[160:163], v[48:51], a[8:11], 0
    s_add_u32 m0, s9, 98304
    ds_read_b128 a[16:19], v21 offset:0
    buffer_load_dwordx4 v16, s[52:55], s5 offen offset:0 lds
    s_waitcnt lgkmcnt(9)
    v_mfma_f32_16x16x32_bf16 v[176:179], v[48:51], a[12:15], 0
    s_waitcnt lgkmcnt(7)
    s_mul_i32 s72, s0, 56
    ds_read_b128 a[20:23], v21 offset:2048
    v_mfma_f32_16x16x32_bf16 v[180:183], v[52:55], a[12:15], 0
    s_add_u32 s72, s72, s1
    ds_read_b128 a[24:27], v21 offset:4096
    v_lshlrev_b32_e64 v84, 2, v0
    v_mfma_f32_16x16x32_bf16 v[164:167], v[52:55], a[8:11], 0
    s_lshl_b32 s72, s72, 12
    ds_read_b128 a[28:31], v21 offset:6144
    v_mfma_f32_16x16x32_bf16 v[148:151], v[52:55], a[4:7], 0
    s_add_u32 s72, s72, 4194304
    ds_read_b64_tr_b16 v[68:69], v13 offset:20480
    v_mfma_f32_16x16x32_bf16 v[132:135], v[52:55], a[0:3], 0
    s_waitcnt lgkmcnt(9)
    s_mov_b32 s14, 0x42804280
    ds_read_b64_tr_b16 v[70:71], v13 offset:20992
    v_mfma_f32_16x16x32_bf16 v[136:139], v[56:59], a[0:3], 0
    s_mul_i32 s2, s1, 37
    ds_read_b64_tr_b16 v[48:49], v12 offset:28672
    buffer_load_dwordx4 v17, s[52:55], s5 offen offset:1024 lds
    v_mfma_f32_16x16x32_bf16 v[152:155], v[56:59], a[4:7], 0
    s_lshr_b32 s2, s2, 8
    ds_read_b64_tr_b16 v[50:51], v12 offset:29184
    v_cvt_f32_u32_e64 v72, v0
    v_mfma_f32_16x16x32_bf16 v[168:171], v[56:59], a[8:11], 0
    s_lshl2_add_u32 s0, s0, s2
    ds_read_b64_tr_b16 v[52:53], v13 offset:28672
    v_mfma_f32_16x16x32_bf16 v[184:187], v[56:59], a[12:15], 0
    s_waitcnt lgkmcnt(11)
    ds_read_b64_tr_b16 v[54:55], v13 offset:29184
    v_mfma_f32_16x16x32_bf16 v[188:191], v[60:63], a[12:15], 0
    v_add_f32 v72, v72, v72
    v_mfma_f32_16x16x32_bf16 v[172:175], v[60:63], a[8:11], 0
    buffer_load_dwordx4 v18, s[52:55], s5 offen offset:2048 lds
    v_mfma_f32_16x16x32_bf16 v[156:159], v[60:63], a[4:7], 0
    v_add_f32_e64 v73, 0x0, v72
    v_mfma_f32_16x16x32_bf16 v[140:143], v[60:63], a[0:3], 0
    s_waitcnt lgkmcnt(6)
    v_add_f32 v74, 0x3f800000, v72
    v_mfma_f32_16x16x32_bf16 v[128:131], v[64:67], a[16:19], v[128:131]
    v_mfma_f32_16x16x32_bf16 v[144:147], v[64:67], a[20:23], v[144:147]
    buffer_load_dwordx4 v19, s[52:55], s5 offen offset:3072 lds
    v_mfma_f32_16x16x32_bf16 v[160:163], v[64:67], a[24:27], v[160:163]
    s_add_u32 s5, s5, 128
    s_cmp_eq_u32 s5, s97
    s_cselect_b32 s96, 896, 0
    v_mfma_f32_16x16x32_bf16 v[176:179], v[64:67], a[28:31], v[176:179]
    s_waitcnt vmcnt(12) lgkmcnt(0)
    s_sub_u32 s5, s5, s96
    s_mul_i32 s0, s0, 256
    s_add_u32 s74, s0, 11534336
    v_mfma_f32_16x16x32_bf16 v[180:183], v[68:71], a[28:31], v[180:183]
    s_barrier
    ds_read_b64_tr_b16 v[56:57], v12 offset:49152
    ds_read_b64_tr_b16 v[58:59], v12 offset:49664
    v_mfma_f32_16x16x32_bf16 v[164:167], v[68:71], a[24:27], v[164:167]
    s_mov_b32 s51, 1
    ds_read_b128 a[32:35], v20 offset:32768
    v_mfma_f32_16x16x32_bf16 v[148:151], v[68:71], a[20:23], v[148:151]
    s_add_u32 m0, s10, 0
    ds_read_b128 a[36:39], v20 offset:34816
    v_mfma_f32_16x16x32_bf16 v[132:135], v[68:71], a[16:19], v[132:135]
    s_mul_i32 s0, s3, 7
    ds_read_b128 a[40:43], v20 offset:36864
    v_mfma_f32_16x16x32_bf16 v[136:139], v[48:51], a[16:19], v[136:139]
    s_mul_i32 s73, s91, 56
    ds_read_b128 a[44:47], v20 offset:38912
    buffer_load_dwordx4 v8, s[56:59], s6 offen offset:0 lds
    v_mfma_f32_16x16x32_bf16 v[152:155], v[48:51], a[20:23], v[152:155]
    s_add_u32 s73, s73, s0
    ds_read_b64_tr_b16 v[60:61], v13 offset:49152
    v_mfma_f32_16x16x32_bf16 v[168:171], v[48:51], a[24:27], v[168:171]
    s_lshl_b32 s73, s73, 12
    ds_read_b64_tr_b16 v[62:63], v13 offset:49664
    v_mfma_f32_16x16x32_bf16 v[184:187], v[48:51], a[28:31], v[184:187]
    s_add_u32 s73, s73, 4194304
    ds_read_b64_tr_b16 v[64:65], v12 offset:57344
    v_cvt_pk_bf16_f32 v73, v73, v74
    v_mfma_f32_16x16x32_bf16 v[188:191], v[52:55], a[28:31], v[188:191]
    ds_read_b64_tr_b16 v[66:67], v12 offset:57856
    v_mfma_f32_16x16x32_bf16 v[172:175], v[52:55], a[24:27], v[172:175]
    ds_read_b64_tr_b16 v[68:69], v13 offset:57344
    v_mfma_f32_16x16x32_bf16 v[156:159], v[52:55], a[20:23], v[156:159]
    ds_read_b64_tr_b16 v[70:71], v13 offset:57856
    buffer_load_dwordx4 v9, s[56:59], s6 offen offset:1024 lds
    v_mfma_f32_16x16x32_bf16 v[140:143], v[52:55], a[16:19], v[140:143]
    s_waitcnt lgkmcnt(6)
    v_subrev_u32 v73, s14, v73
    v_mfma_f32_16x16x32_bf16 v[128:131], v[56:59], a[32:35], v[128:131]
    ds_read_b64_tr_b16 v[48:49], v12 offset:53248
    v_mfma_f32_16x16x32_bf16 v[144:147], v[56:59], a[36:39], v[144:147]
    ds_read_b64_tr_b16 v[50:51], v12 offset:53760
    v_mfma_f32_16x16x32_bf16 v[160:163], v[56:59], a[40:43], v[160:163]
    ds_read_b128 a[48:51], v21 offset:32768
    buffer_load_dwordx4 v10, s[56:59], s6 offen offset:2048 lds
    v_mfma_f32_16x16x32_bf16 v[176:179], v[56:59], a[44:47], v[176:179]
    s_waitcnt lgkmcnt(7)
    ds_read_b128 a[52:55], v21 offset:34816
    v_mfma_f32_16x16x32_bf16 v[180:183], v[60:63], a[44:47], v[180:183]
    ds_read_b128 a[56:59], v21 offset:36864
    v_lshlrev_b32 v76, 2, v73
    v_mfma_f32_16x16x32_bf16 v[164:167], v[60:63], a[40:43], v[164:167]
    ds_read_b128 a[60:63], v21 offset:38912
    v_mfma_f32_16x16x32_bf16 v[148:151], v[60:63], a[36:39], v[148:151]
    ds_read_b64_tr_b16 v[52:53], v13 offset:53248
    buffer_load_dwordx4 v11, s[56:59], s6 offen offset:3072 lds
    v_mfma_f32_16x16x32_bf16 v[132:135], v[60:63], a[32:35], v[132:135]
    s_waitcnt lgkmcnt(9)
    s_add_u32 s6, s6, 229376
    ds_read_b64_tr_b16 v[54:55], v13 offset:53760
    s_cmp_eq_u32 s6, s98
    v_mfma_f32_16x16x32_bf16 v[136:139], v[64:67], a[32:35], v[136:139]
    s_cselect_b32 s96, 1605632, 0
    ds_read_b64_tr_b16 v[56:57], v12 offset:61440
    s_sub_u32 s6, s6, s96
    v_mfma_f32_16x16x32_bf16 v[152:155], v[64:67], a[36:39], v[152:155]
    s_lshl2_add_u32 s1, s91, s3
    ds_read_b64_tr_b16 v[58:59], v12 offset:61952
    v_add_f32 v73, 0x44000000, v72
    v_mfma_f32_16x16x32_bf16 v[168:171], v[64:67], a[40:43], v[168:171]
    s_mul_i32 s76, s1, 256
    ds_read_b64_tr_b16 v[60:61], v13 offset:61440
    s_add_u32 m0, s9, 16384
    v_mfma_f32_16x16x32_bf16 v[184:187], v[64:67], a[44:47], v[184:187]
    s_waitcnt lgkmcnt(11)
    s_add_u32 s76, s76, 11534336
    buffer_load_dwordx4 v16, s[52:55], s5 offen offset:0 lds
    v_mfma_f32_16x16x32_bf16 v[188:191], v[68:71], a[44:47], v[188:191]
    s_mul_i32 s7, s3, 200704
    ds_read_b64_tr_b16 v[62:63], v13 offset:61952
    v_add_f32 v74, 0x44004000, v72
    v_mfma_f32_16x16x32_bf16 v[172:175], v[68:71], a[40:43], v[172:175]
    s_lshl_b32 s1, s88, 7
    v_cvt_pk_bf16_f32 v73, v73, v74
    v_mfma_f32_16x16x32_bf16 v[156:159], v[68:71], a[36:39], v[156:159]
    s_add_u32 s7, s7, s1
    buffer_load_dwordx4 v17, s[52:55], s5 offen offset:1024 lds
    v_mfma_f32_16x16x32_bf16 v[140:143], v[68:71], a[32:35], v[140:143]
    s_waitcnt lgkmcnt(6)
    v_subrev_u32_e64 v73, s14, v73
    v_mfma_f32_16x16x32_bf16 v[128:131], v[48:51], a[48:51], v[128:131]
    v_lshlrev_b32_e64 v77, 2, v73
    v_mfma_f32_16x16x32_bf16 v[144:147], v[48:51], a[52:55], v[144:147]
    buffer_load_dwordx4 v18, s[52:55], s5 offen offset:2048 lds
    v_mfma_f32_16x16x32_bf16 v[160:163], v[48:51], a[56:59], v[160:163]
    v_add_f32 v73, 0x44800000, v72
    v_mfma_f32_16x16x32_bf16 v[176:179], v[48:51], a[60:63], v[176:179]
    s_waitcnt vmcnt(11) lgkmcnt(0)
    s_barrier
    ds_read_b64_tr_b16 v[64:65], v14 offset:16384
    v_mfma_f32_16x16x32_bf16 v[180:183], v[52:55], a[60:63], v[180:183]
    ds_read_b64_tr_b16 v[66:67], v14 offset:16896
    v_mfma_f32_16x16x32_bf16 v[164:167], v[52:55], a[56:59], v[164:167]
    ds_read_b128 a[64:67], v22 offset:0
    v_mfma_f32_16x16x32_bf16 v[148:151], v[52:55], a[52:55], v[148:151]
    ds_read_b128 a[68:71], v22 offset:2048
    buffer_load_dwordx4 v19, s[52:55], s5 offen offset:3072 lds
    v_mfma_f32_16x16x32_bf16 v[132:135], v[52:55], a[48:51], v[132:135]
    s_add_u32 s5, s5, 128
    ds_read_b128 a[72:75], v22 offset:4096
    s_cmp_eq_u32 s5, s97
    v_mfma_f32_16x16x32_bf16 v[136:139], v[56:59], a[48:51], v[136:139]
    s_cselect_b32 s96, 896, 0
    ds_read_b128 a[76:79], v22 offset:6144
    s_sub_u32 s5, s5, s96
    v_mfma_f32_16x16x32_bf16 v[152:155], v[56:59], a[52:55], v[152:155]
    s_mul_i32 s78, s3, 458752
    ds_read_b64_tr_b16 v[68:69], v15 offset:16384
    s_lshl_b32 s1, s4, 8
    v_mfma_f32_16x16x32_bf16 v[168:171], v[56:59], a[56:59], v[168:171]
    s_add_u32 m0, s10, 32768
    ds_read_b64_tr_b16 v[70:71], v15 offset:16896
    buffer_load_dwordx4 v8, s[56:59], s6 offen offset:0 lds
    v_mfma_f32_16x16x32_bf16 v[184:187], v[56:59], a[60:63], v[184:187]
    s_add_u32 s78, s78, s1
    ds_read_b64_tr_b16 v[48:49], v14 offset:24576
    v_mfma_f32_16x16x32_bf16 v[188:191], v[60:63], a[60:63], v[188:191]
    s_add_u32 s78, s78, 262144
    ds_read_b64_tr_b16 v[50:51], v14 offset:25088
    v_mfma_f32_16x16x32_bf16 v[172:175], v[60:63], a[56:59], v[172:175]
    s_lshr_b32 s0, s4, 5
    ds_read_b64_tr_b16 v[52:53], v15 offset:24576
    v_mfma_f32_16x16x32_bf16 v[156:159], v[60:63], a[52:55], v[156:159]
    s_lshl2_add_u32 s0, s0, s3
    ds_read_b64_tr_b16 v[54:55], v15 offset:25088
    v_mfma_f32_16x16x32_bf16 v[140:143], v[60:63], a[48:51], v[140:143]
    s_waitcnt lgkmcnt(6)
    s_bfe_u32 s1, s4, 0x10004
    buffer_load_dwordx4 v9, s[56:59], s6 offen offset:1024 lds
    v_mfma_f32_16x16x32_bf16 v[128:131], v[64:67], a[64:67], v[128:131]
    ds_read_b64_tr_b16 v[56:57], v14 offset:20480
    v_add_f32 v74, 0x44802000, v72
    v_mfma_f32_16x16x32_bf16 v[144:147], v[64:67], a[68:71], v[144:147]
    ds_read_b64_tr_b16 v[58:59], v14 offset:20992
    v_mfma_f32_16x16x32_bf16 v[160:163], v[64:67], a[72:75], v[160:163]
    ds_read_b128 a[80:83], v23 offset:0
    buffer_load_dwordx4 v10, s[56:59], s6 offen offset:2048 lds
    v_mfma_f32_16x16x32_bf16 v[176:179], v[64:67], a[76:79], v[176:179]
    s_waitcnt lgkmcnt(7)
    ds_read_b128 a[84:87], v23 offset:2048
    v_mfma_f32_16x16x32_bf16 v[180:183], v[68:71], a[76:79], v[180:183]
    ds_read_b128 a[88:91], v23 offset:4096
    v_cvt_pk_bf16_f32 v73, v73, v74
    v_mfma_f32_16x16x32_bf16 v[164:167], v[68:71], a[72:75], v[164:167]
    ds_read_b128 a[92:95], v23 offset:6144
    v_mfma_f32_16x16x32_bf16 v[148:151], v[68:71], a[68:71], v[148:151]
    ds_read_b64_tr_b16 v[60:61], v15 offset:20480
    buffer_load_dwordx4 v11, s[56:59], s6 offen offset:3072 lds
    v_mfma_f32_16x16x32_bf16 v[132:135], v[68:71], a[64:67], v[132:135]
    s_waitcnt lgkmcnt(9)
    s_add_u32 s6, s6, 229376
    ds_read_b64_tr_b16 v[62:63], v15 offset:20992
    s_cmp_eq_u32 s6, s98
    v_mfma_f32_16x16x32_bf16 v[136:139], v[48:51], a[64:67], v[136:139]
    s_cselect_b32 s96, 1605632, 0
    ds_read_b64_tr_b16 v[64:65], v14 offset:28672
    s_sub_u32 s6, s6, s96
    v_mfma_f32_16x16x32_bf16 v[152:155], v[48:51], a[68:71], v[152:155]
    s_lshl1_add_u32 s0, s0, s1
    ds_read_b64_tr_b16 v[66:67], v14 offset:29184
    v_subrev_u32_e64 v73, s14, v73
    v_mfma_f32_16x16x32_bf16 v[168:171], v[48:51], a[72:75], v[168:171]
    s_mul_i32 s0, s0, 256
    ds_read_b64_tr_b16 v[68:69], v15 offset:28672
    s_add_u32 m0, s9, 49152
    v_mfma_f32_16x16x32_bf16 v[184:187], v[48:51], a[76:79], v[184:187]
    s_waitcnt lgkmcnt(11)
    s_add_u32 s75, s0, 11599872
    buffer_load_dwordx4 v16, s[52:55], s5 offen offset:0 lds
    v_mfma_f32_16x16x32_bf16 v[188:191], v[52:55], a[76:79], v[188:191]
    s_lshr_b32 s0, s91, 3
    ds_read_b64_tr_b16 v[70:71], v15 offset:29184
    v_lshlrev_b32 v78, 2, v73
    v_mfma_f32_16x16x32_bf16 v[172:175], v[52:55], a[72:75], v[172:175]
    s_lshl2_add_u32 s0, s88, s0
    v_add_f32 v73, 0x44c00000, v72
    v_mfma_f32_16x16x32_bf16 v[156:159], v[52:55], a[68:71], v[156:159]
    s_lshl1_add_u32 s0, s0, s11
    buffer_load_dwordx4 v17, s[52:55], s5 offen offset:1024 lds
    v_mfma_f32_16x16x32_bf16 v[140:143], v[52:55], a[64:67], v[140:143]
    s_waitcnt lgkmcnt(6)
    v_add_f32 v74, 0x44c02000, v72
    v_mfma_f32_16x16x32_bf16 v[128:131], v[56:59], a[80:83], v[128:131]
    v_cvt_pk_bf16_f32 v73, v73, v74
    v_mfma_f32_16x16x32_bf16 v[144:147], v[56:59], a[84:87], v[144:147]
    buffer_load_dwordx4 v18, s[52:55], s5 offen offset:2048 lds
    v_mfma_f32_16x16x32_bf16 v[160:163], v[56:59], a[88:91], v[160:163]
    v_subrev_u32_e64 v73, s14, v73
    v_mfma_f32_16x16x32_bf16 v[176:179], v[56:59], a[92:95], v[176:179]
    s_waitcnt vmcnt(11) lgkmcnt(0)
    s_barrier
    ds_read_b64_tr_b16 v[48:49], v12 offset:0
    v_mfma_f32_16x16x32_bf16 v[180:183], v[60:63], a[92:95], v[180:183]
    ds_read_b64_tr_b16 v[50:51], v12 offset:512
    v_mfma_f32_16x16x32_bf16 v[164:167], v[60:63], a[88:91], v[164:167]
    ds_read_b128 a[96:99], v22 offset:32768
    v_mfma_f32_16x16x32_bf16 v[148:151], v[60:63], a[84:87], v[148:151]
    ds_read_b128 a[100:103], v22 offset:34816
    buffer_load_dwordx4 v19, s[52:55], s5 offen offset:3072 lds
    v_mfma_f32_16x16x32_bf16 v[132:135], v[60:63], a[80:83], v[132:135]
    s_add_u32 s5, s5, 128
    ds_read_b128 a[104:107], v22 offset:36864
    s_cmp_eq_u32 s5, s97
    v_mfma_f32_16x16x32_bf16 v[136:139], v[64:67], a[80:83], v[136:139]
    s_cselect_b32 s96, 896, 0
    ds_read_b128 a[108:111], v22 offset:38912
    s_sub_u32 s5, s5, s96
    v_mfma_f32_16x16x32_bf16 v[152:155], v[64:67], a[84:87], v[152:155]
    s_mul_i32 s77, s0, 256
    ds_read_b64_tr_b16 v[52:53], v13 offset:0
    s_add_u32 s77, s77, 11599872
    v_mfma_f32_16x16x32_bf16 v[168:171], v[64:67], a[88:91], v[168:171]
    s_add_u32 m0, s10, 65536
    ds_read_b64_tr_b16 v[54:55], v13 offset:512
    buffer_load_dwordx4 v8, s[56:59], s6 offen offset:0 lds
    v_mfma_f32_16x16x32_bf16 v[184:187], v[64:67], a[92:95], v[184:187]
    s_lshl1_add_u32 s0, s88, s11
    ds_read_b64_tr_b16 v[56:57], v12 offset:8192
    v_mfma_f32_16x16x32_bf16 v[188:191], v[68:71], a[92:95], v[188:191]
    s_mul_i32 s1, s91, 57344
    ds_read_b64_tr_b16 v[58:59], v12 offset:8704
    v_mfma_f32_16x16x32_bf16 v[172:175], v[68:71], a[88:91], v[172:175]
    s_lshl_b32 s79, s0, 6
    ds_read_b64_tr_b16 v[60:61], v13 offset:8192
    v_mfma_f32_16x16x32_bf16 v[156:159], v[68:71], a[84:87], v[156:159]
    s_add_u32 s81, s79, s1
    ds_read_b64_tr_b16 v[62:63], v13 offset:8704
    v_mfma_f32_16x16x32_bf16 v[140:143], v[68:71], a[80:83], v[140:143]
    s_waitcnt lgkmcnt(6)
    s_add_u32 s79, s79, s13
    buffer_load_dwordx4 v9, s[56:59], s6 offen offset:1024 lds
    v_mfma_f32_16x16x32_bf16 v[128:131], v[48:51], a[96:99], v[128:131]
    ds_read_b64_tr_b16 v[64:65], v12 offset:4096
    v_lshlrev_b32 v79, 2, v73
    v_mfma_f32_16x16x32_bf16 v[144:147], v[48:51], a[100:103], v[144:147]
    ds_read_b64_tr_b16 v[66:67], v12 offset:4608
    v_mfma_f32_16x16x32_bf16 v[160:163], v[48:51], a[104:107], v[160:163]
    ds_read_b128 a[112:115], v23 offset:32768
    buffer_load_dwordx4 v10, s[56:59], s6 offen offset:2048 lds
    v_mfma_f32_16x16x32_bf16 v[176:179], v[48:51], a[108:111], v[176:179]
    s_waitcnt lgkmcnt(7)
    ds_read_b128 a[116:119], v23 offset:34816
    v_mfma_f32_16x16x32_bf16 v[180:183], v[52:55], a[108:111], v[180:183]
    ds_read_b128 a[120:123], v23 offset:36864
    v_cmp_gt_u32 vcc, 64, v0
    v_mfma_f32_16x16x32_bf16 v[164:167], v[52:55], a[104:107], v[164:167]
    ds_read_b128 a[124:127], v23 offset:38912
    v_mfma_f32_16x16x32_bf16 v[148:151], v[52:55], a[100:103], v[148:151]
    ds_read_b64_tr_b16 v[68:69], v13 offset:4096
    buffer_load_dwordx4 v11, s[56:59], s6 offen offset:3072 lds
    v_mfma_f32_16x16x32_bf16 v[132:135], v[52:55], a[96:99], v[132:135]
    s_waitcnt lgkmcnt(9)
    s_add_u32 s6, s6, 229376
    ds_read_b64_tr_b16 v[70:71], v13 offset:4608
    s_cmp_eq_u32 s6, s98
    v_mfma_f32_16x16x32_bf16 v[136:139], v[56:59], a[96:99], v[136:139]
    s_cselect_b32 s96, 1605632, 0
    ds_read_b64_tr_b16 v[48:49], v12 offset:12288
L_st2:
    s_cbranch_execz L_st6
    s_sub_u32 s6, s6, s96
    v_mfma_f32_16x16x32_bf16 v[152:155], v[56:59], a[100:103], v[152:155]
    s_lshl_b32 s79, s79, 6
    ds_read_b64_tr_b16 v[50:51], v12 offset:12800
    v_mul_u32_u24 v75, 0x80008, v0
    v_mfma_f32_16x16x32_bf16 v[168:171], v[56:59], a[104:107], v[168:171]
    s_add_u32 s79, s79, s1
    ds_read_b64_tr_b16 v[52:53], v13 offset:12288
    s_add_u32 m0, s9, 81920
    v_mfma_f32_16x16x32_bf16 v[184:187], v[56:59], a[108:111], v[184:187]
    s_waitcnt lgkmcnt(11)
    s_add_u32 s79, s79, 2097152
    buffer_load_dwordx4 v16, s[52:55], s5 offen offset:0 lds
    v_mfma_f32_16x16x32_bf16 v[188:191], v[60:63], a[108:111], v[188:191]
    s_mul_i32 s0, s13, 28672
    ds_read_b64_tr_b16 v[54:55], v13 offset:12800
    v_add_u32 v75, 0x40000, v75
    v_mfma_f32_16x16x32_bf16 v[172:175], v[60:63], a[104:107], v[172:175]
    s_add_u32 s81, s81, s0
    v_cndmask_b32 v76, v76, v75, vcc
    v_mfma_f32_16x16x32_bf16 v[156:159], v[60:63], a[100:103], v[156:159]
    s_lshl1_add_u32 s0, s91, s13
    buffer_load_dwordx4 v17, s[52:55], s5 offen offset:1024 lds
    v_mfma_f32_16x16x32_bf16 v[140:143], v[60:63], a[96:99], v[140:143]
    s_waitcnt lgkmcnt(6)
    s_lshl_b32 s80, s0, 7
    v_mov_b32_e64 v83, 0
    v_mfma_f32_16x16x32_bf16 v[128:131], v[64:67], a[112:115], v[128:131]
    s_add_u32 s80, s80, 16384
    v_min_u32_e64 v85, 23, v2
    v_mfma_f32_16x16x32_bf16 v[144:147], v[64:67], a[116:119], v[144:147]
    buffer_load_dwordx4 v18, s[52:55], s5 offen offset:2048 lds
    v_mfma_f32_16x16x32_bf16 v[160:163], v[64:67], a[120:123], v[160:163]
    v_lshlrev_b32 v85, 2, v85
    v_mfma_f32_16x16x32_bf16 v[176:179], v[64:67], a[124:127], v[176:179]
    s_waitcnt vmcnt(11) lgkmcnt(0)
    s_barrier
    ds_read_b64_tr_b16 v[56:57], v12 offset:32768
    v_mfma_f32_16x16x32_bf16 v[180:183], v[68:71], a[124:127], v[180:183]
    ds_read_b64_tr_b16 v[58:59], v12 offset:33280
    v_mfma_f32_16x16x32_bf16 v[164:167], v[68:71], a[120:123], v[164:167]
    ds_read_b128 a[128:131], v20 offset:16384
    v_mfma_f32_16x16x32_bf16 v[148:151], v[68:71], a[116:119], v[148:151]
    ds_read_b128 a[132:135], v20 offset:18432
    buffer_load_dwordx4 v19, s[52:55], s5 offen offset:3072 lds
    v_mfma_f32_16x16x32_bf16 v[132:135], v[68:71], a[112:115], v[132:135]
    s_add_u32 m0, s10, 98304
    ds_read_b128 a[136:139], v20 offset:20480
    v_mfma_f32_16x16x32_bf16 v[136:139], v[48:51], a[112:115], v[136:139]
    s_mov_b32 s64, s48
    ds_read_b128 a[140:143], v20 offset:22528
    v_mfma_f32_16x16x32_bf16 v[152:155], v[48:51], a[116:119], v[152:155]
    s_mov_b32 s65, s49
    ds_read_b64_tr_b16 v[60:61], v13 offset:32768
    v_mfma_f32_16x16x32_bf16 v[168:171], v[48:51], a[120:123], v[168:171]
    s_mov_b32 s66, 13631488
    ds_read_b64_tr_b16 v[62:63], v13 offset:33280
    buffer_load_dwordx4 v8, s[56:59], s6 offen offset:0 lds
    v_mfma_f32_16x16x32_bf16 v[184:187], v[48:51], a[124:127], v[184:187]
    s_mov_b32 s67, 0x20000
    ds_read_b64_tr_b16 v[64:65], v12 offset:40960
    v_mfma_f32_16x16x32_bf16 v[188:191], v[52:55], a[124:127], v[188:191]
    ds_read_b64_tr_b16 v[66:67], v12 offset:41472
    v_mfma_f32_16x16x32_bf16 v[172:175], v[52:55], a[120:123], v[172:175]
    ds_read_b64_tr_b16 v[68:69], v13 offset:40960
    v_mfma_f32_16x16x32_bf16 v[156:159], v[52:55], a[116:119], v[156:159]
    ds_read_b64_tr_b16 v[70:71], v13 offset:41472
    v_mfma_f32_16x16x32_bf16 v[140:143], v[52:55], a[112:115], v[140:143]
    s_waitcnt lgkmcnt(6)
    buffer_load_dwordx4 v9, s[56:59], s6 offen offset:1024 lds
    v_mfma_f32_16x16x32_bf16 v[128:131], v[56:59], a[128:131], v[128:131]
    ds_read_b64_tr_b16 v[48:49], v12 offset:36864
    v_mfma_f32_16x16x32_bf16 v[144:147], v[56:59], a[132:135], v[144:147]
    ds_read_b64_tr_b16 v[50:51], v12 offset:37376
    v_lshrrev_b32_e64 v72, 3, v2
    v_mfma_f32_16x16x32_bf16 v[160:163], v[56:59], a[136:139], v[160:163]
    ds_read_b128 a[144:147], v21 offset:16384
    buffer_load_dwordx4 v10, s[56:59], s6 offen offset:2048 lds
    v_mfma_f32_16x16x32_bf16 v[176:179], v[56:59], a[140:143], v[176:179]
    s_waitcnt lgkmcnt(7)
    ds_read_b128 a[148:151], v21 offset:18432
    v_and_b32 v73, 7, v2
    v_mfma_f32_16x16x32_bf16 v[180:183], v[60:63], a[140:143], v[180:183]
    ds_read_b128 a[152:155], v21 offset:20480
    v_lshrrev_b32_e64 v74, 4, v2
    v_mfma_f32_16x16x32_bf16 v[164:167], v[60:63], a[136:139], v[164:167]
    ds_read_b128 a[156:159], v21 offset:22528
    v_mul_u32_u24 v72, 896, v72
    v_mfma_f32_16x16x32_bf16 v[148:151], v[60:63], a[132:135], v[148:151]
    ds_read_b64_tr_b16 v[52:53], v13 offset:36864
    buffer_load_dwordx4 v11, s[56:59], s6 offen offset:3072 lds
    v_mfma_f32_16x16x32_bf16 v[132:135], v[60:63], a[128:131], v[132:135]
    s_waitcnt lgkmcnt(9)
    s_add_u32 m0, s10, 0
    ds_read_b64_tr_b16 v[54:55], v13 offset:37376
    v_lshlrev_b32_e64 v74, 1, v74
    v_mfma_f32_16x16x32_bf16 v[136:139], v[64:67], a[128:131], v[136:139]
    ds_read_b64_tr_b16 v[56:57], v12 offset:45056
    v_xor_b32_e64 v73, v73, v74
    v_mfma_f32_16x16x32_bf16 v[152:155], v[64:67], a[132:135], v[152:155]
    ds_read_b64_tr_b16 v[58:59], v12 offset:45568
    v_lshl_add_u32 v16, v73, 4, v72
    v_mfma_f32_16x16x32_bf16 v[168:171], v[64:67], a[136:139], v[168:171]
    ds_read_b64_tr_b16 v[60:61], v13 offset:45056
    buffer_load_dwordx4 v8, s[56:59], s85 offen offset:0 lds
    v_mfma_f32_16x16x32_bf16 v[184:187], v[64:67], a[140:143], v[184:187]
    s_waitcnt lgkmcnt(11)
    ds_read_b64_tr_b16 v[62:63], v13 offset:45568
    v_add_u32 v17, 6144, v16
    v_mfma_f32_16x16x32_bf16 v[188:191], v[68:71], a[140:143], v[188:191]
    v_add_u32 v18, 12288, v16
    v_add_u32 v19, 18432, v16
    v_mfma_f32_16x16x32_bf16 v[172:175], v[68:71], a[136:139], v[172:175]
    v_cmp_eq_u32 vcc, 0, v0
    v_mov_b32_e64 v72, s83
    v_mfma_f32_16x16x32_bf16 v[156:159], v[68:71], a[132:135], v[156:159]
    buffer_load_dwordx4 v9, s[56:59], s85 offen offset:1024 lds
    v_mfma_f32_16x16x32_bf16 v[140:143], v[68:71], a[128:131], v[140:143]
    s_waitcnt lgkmcnt(6)
    v_cndmask_b32 v7, 0, v72, vcc
    v_mfma_f32_16x16x32_bf16 v[128:131], v[48:51], a[144:147], v[128:131]
    v_mfma_f32_16x16x32_bf16 v[144:147], v[48:51], a[148:151], v[144:147]
    buffer_load_dwordx4 v10, s[56:59], s85 offen offset:2048 lds
    v_mfma_f32_16x16x32_bf16 v[160:163], v[48:51], a[152:155], v[160:163]
    v_mfma_f32_16x16x32_bf16 v[176:179], v[48:51], a[156:159], v[176:179]
    s_waitcnt vmcnt(11) lgkmcnt(0)
    s_barrier
    ds_read_b64_tr_b16 v[64:65], v14 offset:0
    v_mfma_f32_16x16x32_bf16 v[180:183], v[52:55], a[156:159], v[180:183]
    ds_read_b64_tr_b16 v[66:67], v14 offset:512
    v_mfma_f32_16x16x32_bf16 v[164:167], v[52:55], a[152:155], v[164:167]
    ds_read_b128 a[160:163], v20 offset:49152
    v_mfma_f32_16x16x32_bf16 v[148:151], v[52:55], a[148:151], v[148:151]
    ds_read_b128 a[164:167], v20 offset:51200
    buffer_load_dwordx4 v11, s[56:59], s85 offen offset:3072 lds
    v_mfma_f32_16x16x32_bf16 v[132:135], v[52:55], a[144:147], v[132:135]
    s_add_u32 s85, s85, 229376
    ds_read_b128 a[168:171], v20 offset:53248
    s_cmp_eq_u32 s85, s87
    v_mfma_f32_16x16x32_bf16 v[136:139], v[56:59], a[144:147], v[136:139]
    s_cselect_b32 s96, 1605632, 0
    ds_read_b128 a[172:175], v20 offset:55296
    s_sub_u32 s85, s85, s96
    v_mfma_f32_16x16x32_bf16 v[152:155], v[56:59], a[148:151], v[152:155]
    s_add_u32 m0, s10, 16384
    ds_read_b64_tr_b16 v[68:69], v15 offset:0
    v_mfma_f32_16x16x32_bf16 v[168:171], v[56:59], a[152:155], v[168:171]
    ds_read_b64_tr_b16 v[70:71], v15 offset:512
    buffer_load_dwordx4 v8, s[56:59], s85 offen offset:0 lds
    v_mfma_f32_16x16x32_bf16 v[184:187], v[56:59], a[156:159], v[184:187]
    ds_read_b64_tr_b16 v[48:49], v14 offset:8192
    v_mfma_f32_16x16x32_bf16 v[188:191], v[60:63], a[156:159], v[188:191]
    ds_read_b64_tr_b16 v[50:51], v14 offset:8704
    v_mfma_f32_16x16x32_bf16 v[172:175], v[60:63], a[152:155], v[172:175]
    ds_read_b64_tr_b16 v[52:53], v15 offset:8192
    v_mfma_f32_16x16x32_bf16 v[156:159], v[60:63], a[148:151], v[156:159]
    ds_read_b64_tr_b16 v[54:55], v15 offset:8704
    v_mfma_f32_16x16x32_bf16 v[140:143], v[60:63], a[144:147], v[140:143]
    s_waitcnt lgkmcnt(6)
    buffer_load_dwordx4 v9, s[56:59], s85 offen offset:1024 lds
    v_mfma_f32_16x16x32_bf16 v[128:131], v[64:67], a[160:163], v[128:131]
    ds_read_b64_tr_b16 v[56:57], v14 offset:4096
    v_mfma_f32_16x16x32_bf16 v[144:147], v[64:67], a[164:167], v[144:147]
    ds_read_b64_tr_b16 v[58:59], v14 offset:4608
    v_mfma_f32_16x16x32_bf16 v[160:163], v[64:67], a[168:171], v[160:163]
    ds_read_b128 a[176:179], v21 offset:49152
    buffer_load_dwordx4 v10, s[56:59], s85 offen offset:2048 lds
    v_mfma_f32_16x16x32_bf16 v[176:179], v[64:67], a[172:175], v[176:179]
    s_waitcnt lgkmcnt(7)
    ds_read_b128 a[180:183], v21 offset:51200
    v_mfma_f32_16x16x32_bf16 v[180:183], v[68:71], a[172:175], v[180:183]
    ds_read_b128 a[184:187], v21 offset:53248
    v_mfma_f32_16x16x32_bf16 v[164:167], v[68:71], a[168:171], v[164:167]
    ds_read_b128 a[188:191], v21 offset:55296
    v_mfma_f32_16x16x32_bf16 v[148:151], v[68:71], a[164:167], v[148:151]
    ds_read_b64_tr_b16 v[60:61], v15 offset:4096
    buffer_load_dwordx4 v11, s[56:59], s85 offen offset:3072 lds
    v_mfma_f32_16x16x32_bf16 v[132:135], v[68:71], a[160:163], v[132:135]
    s_waitcnt lgkmcnt(9)
    s_add_u32 s85, s85, 229376
    ds_read_b64_tr_b16 v[62:63], v15 offset:4608
    s_cmp_eq_u32 s85, s87
    v_mfma_f32_16x16x32_bf16 v[136:139], v[48:51], a[160:163], v[136:139]
    s_cselect_b32 s96, 1605632, 0
    ds_read_b64_tr_b16 v[64:65], v14 offset:12288
    s_sub_u32 s85, s85, s96
    v_mfma_f32_16x16x32_bf16 v[152:155], v[48:51], a[164:167], v[152:155]
    s_add_u32 m0, s10, 32768
    ds_read_b64_tr_b16 v[66:67], v14 offset:12800
    v_mfma_f32_16x16x32_bf16 v[168:171], v[48:51], a[168:171], v[168:171]
    ds_read_b64_tr_b16 v[68:69], v15 offset:12288
    buffer_load_dwordx4 v8, s[56:59], s85 offen offset:0 lds
    v_mfma_f32_16x16x32_bf16 v[184:187], v[48:51], a[172:175], v[184:187]
    s_waitcnt lgkmcnt(11)
    ds_read_b64_tr_b16 v[70:71], v15 offset:12800
    v_mfma_f32_16x16x32_bf16 v[188:191], v[52:55], a[172:175], v[188:191]
    v_mfma_f32_16x16x32_bf16 v[172:175], v[52:55], a[168:171], v[172:175]
    v_mfma_f32_16x16x32_bf16 v[156:159], v[52:55], a[164:167], v[156:159]
    buffer_load_dwordx4 v9, s[56:59], s85 offen offset:1024 lds
    v_mfma_f32_16x16x32_bf16 v[140:143], v[52:55], a[160:163], v[140:143]
    s_waitcnt lgkmcnt(6)
    v_mfma_f32_16x16x32_bf16 v[128:131], v[56:59], a[176:179], v[128:131]
    v_mfma_f32_16x16x32_bf16 v[144:147], v[56:59], a[180:183], v[144:147]
    buffer_load_dwordx4 v10, s[56:59], s85 offen offset:2048 lds
    v_mfma_f32_16x16x32_bf16 v[160:163], v[56:59], a[184:187], v[160:163]
    v_mfma_f32_16x16x32_bf16 v[176:179], v[56:59], a[188:191], v[176:179]
    s_waitcnt vmcnt(11) lgkmcnt(0)
    s_barrier
    ds_read_b64_tr_b16 v[48:49], v14 offset:32768
    v_mfma_f32_16x16x32_bf16 v[180:183], v[60:63], a[188:191], v[180:183]
    ds_read_b64_tr_b16 v[50:51], v14 offset:33280
    v_mfma_f32_16x16x32_bf16 v[164:167], v[60:63], a[184:187], v[164:167]
    ds_read_b128 a[192:195], v22 offset:16384
    v_mfma_f32_16x16x32_bf16 v[148:151], v[60:63], a[180:183], v[148:151]
    ds_read_b128 a[196:199], v22 offset:18432
    buffer_load_dwordx4 v11, s[56:59], s85 offen offset:3072 lds
    v_mfma_f32_16x16x32_bf16 v[132:135], v[60:63], a[176:179], v[132:135]
    s_add_u32 s85, s85, 229376
    ds_read_b128 a[200:203], v22 offset:20480
    s_cmp_eq_u32 s85, s87
    v_mfma_f32_16x16x32_bf16 v[136:139], v[64:67], a[176:179], v[136:139]
    s_cselect_b32 s96, 1605632, 0
    ds_read_b128 a[204:207], v22 offset:22528
    s_sub_u32 s85, s85, s96
    v_mfma_f32_16x16x32_bf16 v[152:155], v[64:67], a[180:183], v[152:155]
    s_add_u32 m0, s10, 49152
    ds_read_b64_tr_b16 v[52:53], v15 offset:32768
    v_mfma_f32_16x16x32_bf16 v[168:171], v[64:67], a[184:187], v[168:171]
    ds_read_b64_tr_b16 v[54:55], v15 offset:33280
    buffer_load_dwordx4 v8, s[56:59], s85 offen offset:0 lds
    v_mfma_f32_16x16x32_bf16 v[184:187], v[64:67], a[188:191], v[184:187]
    ds_read_b64_tr_b16 v[56:57], v14 offset:40960
    v_mfma_f32_16x16x32_bf16 v[188:191], v[68:71], a[188:191], v[188:191]
    ds_read_b64_tr_b16 v[58:59], v14 offset:41472
    v_mfma_f32_16x16x32_bf16 v[172:175], v[68:71], a[184:187], v[172:175]
    ds_read_b64_tr_b16 v[60:61], v15 offset:40960
    v_mfma_f32_16x16x32_bf16 v[156:159], v[68:71], a[180:183], v[156:159]
    ds_read_b64_tr_b16 v[62:63], v15 offset:41472
    v_mfma_f32_16x16x32_bf16 v[140:143], v[68:71], a[176:179], v[140:143]
    s_waitcnt lgkmcnt(6)
    buffer_load_dwordx4 v9, s[56:59], s85 offen offset:1024 lds
    v_mfma_f32_16x16x32_bf16 v[128:131], v[48:51], a[192:195], v[128:131]
    ds_read_b64_tr_b16 v[64:65], v14 offset:36864
    v_mfma_f32_16x16x32_bf16 v[144:147], v[48:51], a[196:199], v[144:147]
    ds_read_b64_tr_b16 v[66:67], v14 offset:37376
    v_mfma_f32_16x16x32_bf16 v[160:163], v[48:51], a[200:203], v[160:163]
    ds_read_b128 a[208:211], v23 offset:16384
    buffer_load_dwordx4 v10, s[56:59], s85 offen offset:2048 lds
    v_mfma_f32_16x16x32_bf16 v[176:179], v[48:51], a[204:207], v[176:179]
    s_waitcnt lgkmcnt(7)
    ds_read_b128 a[212:215], v23 offset:18432
    v_mfma_f32_16x16x32_bf16 v[180:183], v[52:55], a[204:207], v[180:183]
    ds_read_b128 a[216:219], v23 offset:20480
    v_mfma_f32_16x16x32_bf16 v[164:167], v[52:55], a[200:203], v[164:167]
    ds_read_b128 a[220:223], v23 offset:22528
    v_mfma_f32_16x16x32_bf16 v[148:151], v[52:55], a[196:199], v[148:151]
    ds_read_b64_tr_b16 v[68:69], v15 offset:36864
    v_mfma_f32_16x16x32_bf16 v[132:135], v[52:55], a[192:195], v[132:135]
    s_waitcnt lgkmcnt(9)
    ds_read_b64_tr_b16 v[70:71], v15 offset:37376
    v_mfma_f32_16x16x32_bf16 v[136:139], v[56:59], a[192:195], v[136:139]
    ds_read_b64_tr_b16 v[48:49], v14 offset:45056
    buffer_load_dwordx4 v11, s[56:59], s85 offen offset:3072 lds
    v_mfma_f32_16x16x32_bf16 v[152:155], v[56:59], a[196:199], v[152:155]
    s_add_u32 s85, s85, 229376
    ds_read_b64_tr_b16 v[50:51], v14 offset:45568
    s_cmp_eq_u32 s85, s87
    v_mfma_f32_16x16x32_bf16 v[168:171], v[56:59], a[200:203], v[168:171]
    s_cselect_b32 s96, 1605632, 0
    ds_read_b64_tr_b16 v[52:53], v15 offset:45056
    s_sub_u32 s85, s85, s96
    v_mfma_f32_16x16x32_bf16 v[184:187], v[56:59], a[204:207], v[184:187]
    s_waitcnt lgkmcnt(11)
    s_add_u32 m0, s10, 65536
    ds_read_b64_tr_b16 v[54:55], v15 offset:45568
    v_mfma_f32_16x16x32_bf16 v[188:191], v[60:63], a[204:207], v[188:191]
    v_mov_b32 v20, v76
    v_mfma_f32_16x16x32_bf16 v[172:175], v[60:63], a[200:203], v[172:175]
    buffer_load_dwordx4 v8, s[56:59], s85 offen offset:0 lds
    v_mfma_f32_16x16x32_bf16 v[156:159], v[60:63], a[196:199], v[156:159]
    v_mov_b32_e64 v21, v77
    v_mfma_f32_16x16x32_bf16 v[140:143], v[60:63], a[192:195], v[140:143]
    s_waitcnt lgkmcnt(6)
    v_mov_b32 v22, v78
    v_mfma_f32_16x16x32_bf16 v[128:131], v[64:67], a[208:211], v[128:131]
    v_mov_b32_e64 v23, v79
    v_mfma_f32_16x16x32_bf16 v[144:147], v[64:67], a[212:215], v[144:147]
    buffer_load_dwordx4 v9, s[56:59], s85 offen offset:1024 lds
    v_mfma_f32_16x16x32_bf16 v[160:163], v[64:67], a[216:219], v[160:163]
    v_mfma_f32_16x16x32_bf16 v[176:179], v[64:67], a[220:223], v[176:179]
    s_waitcnt vmcnt(14) lgkmcnt(0)
    s_barrier
    ds_read_b64_tr_b16 v[56:57], v12 offset:0
    v_mfma_f32_16x16x32_bf16 v[180:183], v[68:71], a[220:223], v[180:183]
    ds_read_b64_tr_b16 v[58:59], v12 offset:512
    v_mfma_f32_16x16x32_bf16 v[164:167], v[68:71], a[216:219], v[164:167]
    v_mfma_f32_16x16x32_bf16 v[148:151], v[68:71], a[212:215], v[148:151]
    ds_read_b64_tr_b16 v[60:61], v13 offset:0
    v_mfma_f32_16x16x32_bf16 v[132:135], v[68:71], a[208:211], v[132:135]
    ds_read_b64_tr_b16 v[62:63], v13 offset:512
    v_mfma_f32_16x16x32_bf16 v[136:139], v[48:51], a[208:211], v[136:139]
    buffer_load_dwordx4 v10, s[56:59], s85 offen offset:2048 lds
    v_mfma_f32_16x16x32_bf16 v[152:155], v[48:51], a[212:215], v[152:155]
    ds_read_b64_tr_b16 v[64:65], v12 offset:8192
    v_mfma_f32_16x16x32_bf16 v[168:171], v[48:51], a[216:219], v[168:171]
    ds_read_b64_tr_b16 v[66:67], v12 offset:8704
    v_mfma_f32_16x16x32_bf16 v[184:187], v[48:51], a[220:223], v[184:187]
    v_mfma_f32_16x16x32_bf16 v[188:191], v[52:55], a[220:223], v[188:191]
    ds_read_b64_tr_b16 v[68:69], v13 offset:8192
    v_mfma_f32_16x16x32_bf16 v[172:175], v[52:55], a[216:219], v[172:175]
    ds_read_b64_tr_b16 v[70:71], v13 offset:8704
    v_mfma_f32_16x16x32_bf16 v[156:159], v[52:55], a[212:215], v[156:159]
    buffer_load_dwordx4 v11, s[56:59], s85 offen offset:3072 lds
    v_mfma_f32_16x16x32_bf16 v[140:143], v[52:55], a[208:211], v[140:143]
    s_waitcnt lgkmcnt(6)
    s_add_u32 s85, s85, 229376
    s_cmp_eq_u32 s85, s87
    s_cselect_b32 s96, 1605632, 0
    s_sub_u32 s85, s85, s96
L_g1a:
    s_add_u32 m0, s10, 81920
    s_nop 0
    buffer_load_dwordx4 v8, s[56:59], s85 offen offset:0 lds
    buffer_load_dwordx4 v9, s[56:59], s85 offen offset:1024 lds
    v_pk_mul_f32 v[72:73], v[128:129], v[128:129]
    v_pk_mul_f32 v[136:137], v[136:137], v[128:129]
    v_pk_mul_f32 v[74:75], v[130:131], v[130:131]
    v_pk_fma_f32 v[72:73], v[72:73], v[80:81], s[92:93]
    v_pk_mul_f32 v[138:139], v[138:139], v[130:131]
    v_pk_fma_f32 v[74:75], v[74:75], v[80:81], s[92:93]
    v_pk_mul_f32 v[72:73], v[72:73], v[128:129]
    v_pk_mul_f32 v[76:77], v[132:133], v[132:133]
    v_pk_mul_f32 v[74:75], v[74:75], v[130:131]
    v_exp_f32 v72, v72
    v_exp_f32 v73, v73
    v_exp_f32 v74, v74
    v_pk_add_f32 v[72:73], v[72:73], s[94:95]
    v_exp_f32 v75, v75
    v_rcp_f32 v72, v72
    v_rcp_f32 v73, v73
    v_pk_add_f32 v[74:75], v[74:75], s[94:95]
    v_pk_mul_f32 v[140:141], v[140:141], v[132:133]
    v_pk_mul_f32 v[72:73], v[72:73], v[136:137]
    v_rcp_f32 v74, v74
    v_cvt_pk_bf16_f32 v128, v72, v73
    v_rcp_f32 v75, v75
    v_pk_fma_f32 v[76:77], v[76:77], v[80:81], s[92:93]
    v_pk_mul_f32 v[78:79], v[134:135], v[134:135]
    v_pk_mul_f32 v[74:75], v[74:75], v[138:139]
    v_pk_mul_f32 v[76:77], v[76:77], v[132:133]
    v_pk_mul_f32 v[142:143], v[142:143], v[134:135]
    v_cvt_pk_bf16_f32 v129, v74, v75
    v_exp_f32 v76, v76
    v_exp_f32 v77, v77
    v_pk_fma_f32 v[78:79], v[78:79], v[80:81], s[92:93]
    v_pk_mul_f32 v[72:73], v[144:145], v[144:145]
    v_pk_add_f32 v[76:77], v[76:77], s[94:95]
    v_pk_mul_f32 v[78:79], v[78:79], v[134:135]
    v_pk_mul_f32 v[152:153], v[152:153], v[144:145]
    v_rcp_f32 v76, v76
    v_rcp_f32 v77, v77
    v_exp_f32 v78, v78
    v_pk_mul_f32 v[76:77], v[76:77], v[140:141]
    v_exp_f32 v79, v79
    v_cvt_pk_bf16_f32 v130, v76, v77
    v_pk_fma_f32 v[72:73], v[72:73], v[80:81], s[92:93]
    v_pk_add_f32 v[78:79], v[78:79], s[94:95]
    v_pk_mul_f32 v[74:75], v[146:147], v[146:147]
    v_pk_mul_f32 v[72:73], v[72:73], v[144:145]
    v_rcp_f32 v78, v78
    v_rcp_f32 v79, v79
    v_exp_f32 v72, v72
    v_pk_mul_f32 v[78:79], v[78:79], v[142:143]
    v_exp_f32 v73, v73
    v_cvt_pk_bf16_f32 v131, v78, v79
    v_pk_mul_f32 v[154:155], v[154:155], v[146:147]
    v_pk_add_f32 v[72:73], v[72:73], s[94:95]
    v_pk_fma_f32 v[74:75], v[74:75], v[80:81], s[92:93]
    v_pk_mul_f32 v[76:77], v[148:149], v[148:149]
    v_rcp_f32 v72, v72
    v_rcp_f32 v73, v73
    v_pk_mul_f32 v[74:75], v[74:75], v[146:147]
    v_pk_mul_f32 v[156:157], v[156:157], v[148:149]
    v_pk_mul_f32 v[72:73], v[72:73], v[152:153]
    v_exp_f32 v74, v74
    v_cvt_pk_bf16_f32 v144, v72, v73
    v_exp_f32 v75, v75
    v_pk_fma_f32 v[76:77], v[76:77], v[80:81], s[92:93]
    v_pk_mul_f32 v[78:79], v[150:151], v[150:151]
    v_pk_add_f32 v[74:75], v[74:75], s[94:95]
    v_pk_mul_f32 v[76:77], v[76:77], v[148:149]
    v_pk_mul_f32 v[158:159], v[158:159], v[150:151]
    v_rcp_f32 v74, v74
    v_rcp_f32 v75, v75
    v_exp_f32 v76, v76
    v_pk_mul_f32 v[74:75], v[74:75], v[154:155]
    v_exp_f32 v77, v77
    v_cvt_pk_bf16_f32 v145, v74, v75
    v_pk_fma_f32 v[78:79], v[78:79], v[80:81], s[92:93]
    v_pk_add_f32 v[76:77], v[76:77], s[94:95]
    v_pk_mul_f32 v[78:79], v[78:79], v[150:151]
    v_rcp_f32 v76, v76
    v_rcp_f32 v77, v77
    v_exp_f32_e64 v78, v78
    v_pk_mul_f32 v[76:77], v[76:77], v[156:157]
    v_exp_f32 v79, v79
    v_cvt_pk_bf16_f32 v146, v76, v77
    v_pk_add_f32 v[78:79], v[78:79], s[94:95]
    v_rcp_f32 v78, v78
    v_rcp_f32 v79, v79
    s_nop 0
    v_pk_mul_f32 v[78:79], v[78:79], v[158:159]
    v_cvt_pk_bf16_f32 v147, v78, v79
    buffer_store_dwordx4 v[128:131], v1, s[64:67], s72 offen offset:0 sc1
    buffer_store_dwordx4 v[144:147], v1, s[64:67], s72 offen offset:1024 sc1
L_g1b:
    v_mfma_f32_16x16x32_bf16 v[192:195], v[56:59], a[0:3], 0
    ds_read_b64_tr_b16 v[48:49], v12 offset:4096
    v_mfma_f32_16x16x32_bf16 v[208:211], v[56:59], a[4:7], 0
    ds_read_b64_tr_b16 v[50:51], v12 offset:4608
    v_mfma_f32_16x16x32_bf16 v[128:131], v[56:59], a[8:11], 0
    v_mul_f32 v72, v160, v160
    v_mul_f32 v73, v161, v161
    v_mfma_f32_16x16x32_bf16 v[144:147], v[56:59], a[12:15], 0
    s_waitcnt lgkmcnt(6)
    ds_read_b64_tr_b16 v[52:53], v13 offset:4096
    v_mul_f32 v168, v168, v160
    v_mfma_f32_16x16x32_bf16 v[148:151], v[60:63], a[12:15], 0
    ds_read_b64_tr_b16 v[54:55], v13 offset:4608
    v_mfma_f32_16x16x32_bf16 v[132:135], v[60:63], a[8:11], 0
    buffer_load_dwordx4 v10, s[56:59], s85 offen offset:2048 lds
    v_mfma_f32_16x16x32_bf16 v[212:215], v[60:63], a[4:7], 0
    ds_read_b64_tr_b16 v[56:57], v12 offset:12288
    v_fma_f32 v72, v72, v80, s92
    v_mfma_f32_16x16x32_bf16 v[196:199], v[60:63], a[0:3], 0
    s_waitcnt lgkmcnt(7)
    ds_read_b64_tr_b16 v[58:59], v12 offset:12800
    v_fma_f32 v73, v73, v80, s92
    v_mfma_f32_16x16x32_bf16 v[200:203], v[64:67], a[0:3], 0
    v_mul_f32 v169, v169, v161
    v_mfma_f32_16x16x32_bf16 v[216:219], v[64:67], a[4:7], 0
    ds_read_b64_tr_b16 v[60:61], v13 offset:12288
    v_mul_f32 v72, v72, v160
    v_mfma_f32_16x16x32_bf16 v[136:139], v[64:67], a[8:11], 0
    ds_read_b64_tr_b16 v[62:63], v13 offset:12800
    v_mul_f32 v73, v73, v161
    v_mfma_f32_16x16x32_bf16 v[152:155], v[64:67], a[12:15], 0
    s_waitcnt lgkmcnt(8)
    v_exp_f32 v72, v72
    v_mfma_f32_16x16x32_bf16 v[156:159], v[68:71], a[12:15], 0
    v_exp_f32_e64 v73, v73
    v_mfma_f32_16x16x32_bf16 v[140:143], v[68:71], a[8:11], 0
    buffer_load_dwordx4 v11, s[56:59], s85 offen offset:3072 lds
    v_mfma_f32_16x16x32_bf16 v[220:223], v[68:71], a[4:7], 0
    s_add_u32 s85, s85, 229376
    s_cmp_eq_u32 s85, s87
    s_cselect_b32 s96, 1605632, 0
    v_mfma_f32_16x16x32_bf16 v[204:207], v[68:71], a[0:3], 0
    s_waitcnt lgkmcnt(6)
    s_sub_u32 s85, s85, s96
    v_add_f32 v72, 1.0, v72
    v_add_f32_e64 v73, 1.0, v73
    v_mfma_f32_16x16x32_bf16 v[192:195], v[48:51], a[16:19], v[192:195]
    s_add_u32 m0, s10, 98304
    v_rcp_f32 v72, v72
    v_mfma_f32_16x16x32_bf16 v[208:211], v[48:51], a[20:23], v[208:211]
    v_rcp_f32 v73, v73
    v_mfma_f32_16x16x32_bf16 v[128:131], v[48:51], a[24:27], v[128:131]
    v_mul_f32_e64 v72, v72, v168
    v_mfma_f32_16x16x32_bf16 v[144:147], v[48:51], a[28:31], v[144:147]
    s_waitcnt vmcnt(18) lgkmcnt(0)
    s_barrier
    ds_read_b64_tr_b16 v[64:65], v12 offset:16384
    v_mfma_f32_16x16x32_bf16 v[148:151], v[52:55], a[28:31], v[148:151]
    ds_read_b64_tr_b16 v[66:67], v12 offset:16896
    v_mfma_f32_16x16x32_bf16 v[132:135], v[52:55], a[24:27], v[132:135]
    buffer_load_dwordx4 v8, s[56:59], s85 offen offset:0 lds
    v_mfma_f32_16x16x32_bf16 v[212:215], v[52:55], a[20:23], v[212:215]
    ds_read_b64_tr_b16 v[68:69], v13 offset:16384
    v_mfma_f32_16x16x32_bf16 v[196:199], v[52:55], a[16:19], v[196:199]
    ds_read_b64_tr_b16 v[70:71], v13 offset:16896
    v_mul_f32 v73, v73, v169
    v_mfma_f32_16x16x32_bf16 v[200:203], v[56:59], a[16:19], v[200:203]
    v_cvt_pk_bf16_f32 v160, v72, v73
    v_mul_f32 v74, v162, v162
    v_mfma_f32_16x16x32_bf16 v[216:219], v[56:59], a[20:23], v[216:219]
    ds_read_b64_tr_b16 v[48:49], v12 offset:24576
    v_mfma_f32_16x16x32_bf16 v[136:139], v[56:59], a[24:27], v[136:139]
    ds_read_b64_tr_b16 v[50:51], v12 offset:25088
    v_mul_f32 v75, v163, v163
    v_mfma_f32_16x16x32_bf16 v[152:155], v[56:59], a[28:31], v[152:155]
    v_mul_f32 v170, v170, v162
    v_fma_f32 v74, v74, v80, s92
    v_mfma_f32_16x16x32_bf16 v[156:159], v[60:63], a[28:31], v[156:159]
    ds_read_b64_tr_b16 v[52:53], v13 offset:24576
    v_mfma_f32_16x16x32_bf16 v[140:143], v[60:63], a[24:27], v[140:143]
    ds_read_b64_tr_b16 v[54:55], v13 offset:25088
    v_fma_f32 v75, v75, v80, s92
    v_mfma_f32_16x16x32_bf16 v[220:223], v[60:63], a[20:23], v[220:223]
    buffer_load_dwordx4 v9, s[56:59], s85 offen offset:1024 lds
    v_mfma_f32_16x16x32_bf16 v[204:207], v[60:63], a[16:19], v[204:207]
    s_waitcnt lgkmcnt(6)
    v_mul_f32 v171, v171, v163
    v_mfma_f32_16x16x32_bf16 v[192:195], v[64:67], a[32:35], v[192:195]
    ds_read_b64_tr_b16 v[56:57], v12 offset:20480
    v_mul_f32_e64 v74, v74, v162
    v_mfma_f32_16x16x32_bf16 v[208:211], v[64:67], a[36:39], v[208:211]
    ds_read_b64_tr_b16 v[58:59], v12 offset:20992
    v_mul_f32 v75, v75, v163
    v_mfma_f32_16x16x32_bf16 v[128:131], v[64:67], a[40:43], v[128:131]
    v_exp_f32 v74, v74
    v_mfma_f32_16x16x32_bf16 v[144:147], v[64:67], a[44:47], v[144:147]
    s_waitcnt lgkmcnt(6)
    ds_read_b64_tr_b16 v[60:61], v13 offset:20480
    v_mfma_f32_16x16x32_bf16 v[148:151], v[68:71], a[44:47], v[148:151]
    ds_read_b64_tr_b16 v[62:63], v13 offset:20992
    v_mfma_f32_16x16x32_bf16 v[132:135], v[68:71], a[40:43], v[132:135]
    buffer_load_dwordx4 v10, s[56:59], s85 offen offset:2048 lds
    v_mfma_f32_16x16x32_bf16 v[212:215], v[68:71], a[36:39], v[212:215]
    ds_read_b64_tr_b16 v[64:65], v12 offset:28672
    v_mfma_f32_16x16x32_bf16 v[196:199], v[68:71], a[32:35], v[196:199]
    s_waitcnt lgkmcnt(7)
    ds_read_b64_tr_b16 v[66:67], v12 offset:29184
    v_mfma_f32_16x16x32_bf16 v[200:203], v[48:51], a[32:35], v[200:203]
    v_exp_f32_e64 v75, v75
    v_mfma_f32_16x16x32_bf16 v[216:219], v[48:51], a[36:39], v[216:219]
    ds_read_b64_tr_b16 v[68:69], v13 offset:28672
    v_add_f32_e64 v74, 1.0, v74
    v_mfma_f32_16x16x32_bf16 v[136:139], v[48:51], a[40:43], v[136:139]
    ds_read_b64_tr_b16 v[70:71], v13 offset:29184
    v_add_f32 v75, 1.0, v75
    v_mfma_f32_16x16x32_bf16 v[152:155], v[48:51], a[44:47], v[152:155]
    s_waitcnt lgkmcnt(8)
    v_rcp_f32_e64 v74, v74
    v_mfma_f32_16x16x32_bf16 v[156:159], v[52:55], a[44:47], v[156:159]
    v_rcp_f32_e64 v75, v75
    v_mfma_f32_16x16x32_bf16 v[140:143], v[52:55], a[40:43], v[140:143]
    buffer_load_dwordx4 v11, s[56:59], s85 offen offset:3072 lds
    v_mfma_f32_16x16x32_bf16 v[220:223], v[52:55], a[36:39], v[220:223]
    s_add_u32 m0, s9, 0
    v_mul_f32 v74, v74, v170
    v_mul_f32 v75, v75, v171
    v_mfma_f32_16x16x32_bf16 v[204:207], v[52:55], a[32:35], v[204:207]
    s_waitcnt lgkmcnt(6)
    v_cvt_pk_bf16_f32 v161, v74, v75
    v_mul_f32 v76, v164, v164
    v_mfma_f32_16x16x32_bf16 v[192:195], v[56:59], a[48:51], v[192:195]
    v_mul_f32 v77, v165, v165
    v_mul_f32_e64 v172, v172, v164
    v_mfma_f32_16x16x32_bf16 v[208:211], v[56:59], a[52:55], v[208:211]
    v_fma_f32 v76, v76, v80, s92
    v_fma_f32 v77, v77, v80, s92
    v_mfma_f32_16x16x32_bf16 v[128:131], v[56:59], a[56:59], v[128:131]
    v_mul_f32 v173, v173, v165
    v_mul_f32 v76, v76, v164
    v_mfma_f32_16x16x32_bf16 v[144:147], v[56:59], a[60:63], v[144:147]
    s_waitcnt vmcnt(18) lgkmcnt(0)
    s_barrier
    ds_read_b64_tr_b16 v[48:49], v12 offset:32768
    v_mfma_f32_16x16x32_bf16 v[148:151], v[60:63], a[60:63], v[148:151]
    ds_read_b64_tr_b16 v[50:51], v12 offset:33280
    v_mul_f32_e64 v77, v77, v165
    v_mfma_f32_16x16x32_bf16 v[132:135], v[60:63], a[56:59], v[132:135]
    buffer_load_dwordx4 v16, s[60:63], s7 offen offset:0 lds
    v_mfma_f32_16x16x32_bf16 v[212:215], v[60:63], a[52:55], v[212:215]
    ds_read_b64_tr_b16 v[52:53], v13 offset:32768
    v_mfma_f32_16x16x32_bf16 v[196:199], v[60:63], a[48:51], v[196:199]
    ds_read_b64_tr_b16 v[54:55], v13 offset:33280
    v_mfma_f32_16x16x32_bf16 v[200:203], v[64:67], a[48:51], v[200:203]
    v_exp_f32_e64 v76, v76
    v_mfma_f32_16x16x32_bf16 v[216:219], v[64:67], a[52:55], v[216:219]
    ds_read_b64_tr_b16 v[56:57], v12 offset:40960
    v_mfma_f32_16x16x32_bf16 v[136:139], v[64:67], a[56:59], v[136:139]
L_st3:
    s_cbranch_execz L_hopret
    ds_read_b64_tr_b16 v[58:59], v12 offset:41472
    v_mfma_f32_16x16x32_bf16 v[152:155], v[64:67], a[60:63], v[152:155]
    v_exp_f32 v77, v77
    v_mfma_f32_16x16x32_bf16 v[156:159], v[68:71], a[60:63], v[156:159]
    ds_read_b64_tr_b16 v[60:61], v13 offset:40960
    v_add_f32_e64 v76, 1.0, v76
    v_mfma_f32_16x16x32_bf16 v[140:143], v[68:71], a[56:59], v[140:143]
    ds_read_b64_tr_b16 v[62:63], v13 offset:41472
    v_add_f32_e64 v77, 1.0, v77
    v_mfma_f32_16x16x32_bf16 v[220:223], v[68:71], a[52:55], v[220:223]
    buffer_load_dwordx4 v17, s[60:63], s7 offen offset:1024 lds
    v_mfma_f32_16x16x32_bf16 v[204:207], v[68:71], a[48:51], v[204:207]
    s_waitcnt lgkmcnt(6)
    v_mul_f32 v78, v166, v166
    v_mfma_f32_16x16x32_bf16 v[192:195], v[48:51], a[64:67], v[192:195]
    ds_read_b64_tr_b16 v[64:65], v12 offset:36864
    v_rcp_f32 v76, v76
    v_mfma_f32_16x16x32_bf16 v[208:211], v[48:51], a[68:71], v[208:211]
    ds_read_b64_tr_b16 v[66:67], v12 offset:37376
    v_rcp_f32 v77, v77
    v_mfma_f32_16x16x32_bf16 v[128:131], v[48:51], a[72:75], v[128:131]
    buffer_load_dwordx4 v18, s[60:63], s7 offen offset:2048 lds
    v_mfma_f32_16x16x32_bf16 v[144:147], v[48:51], a[76:79], v[144:147]
    s_waitcnt lgkmcnt(6)
    ds_read_b64_tr_b16 v[68:69], v13 offset:36864
    v_mul_f32 v76, v76, v172
    v_mfma_f32_16x16x32_bf16 v[148:151], v[52:55], a[76:79], v[148:151]
    ds_read_b64_tr_b16 v[70:71], v13 offset:37376
    v_mul_f32_e64 v77, v77, v173
    v_mfma_f32_16x16x32_bf16 v[132:135], v[52:55], a[72:75], v[132:135]
    v_cvt_pk_bf16_f32 v162, v76, v77
    v_mfma_f32_16x16x32_bf16 v[212:215], v[52:55], a[68:71], v[212:215]
    ds_read_b64_tr_b16 v[48:49], v12 offset:45056
    v_mul_f32 v79, v167, v167
    v_mfma_f32_16x16x32_bf16 v[196:199], v[52:55], a[64:67], v[196:199]
    s_waitcnt lgkmcnt(7)
    ds_read_b64_tr_b16 v[50:51], v12 offset:45568
    v_mul_f32_e64 v174, v174, v166
    v_mfma_f32_16x16x32_bf16 v[200:203], v[56:59], a[64:67], v[200:203]
    buffer_load_dwordx4 v19, s[60:63], s7 offen offset:3072 lds
    v_mfma_f32_16x16x32_bf16 v[216:219], v[56:59], a[68:71], v[216:219]
    s_add_u32 s7, s7, 28672
    ds_read_b64_tr_b16 v[52:53], v13 offset:45056
    v_fma_f32 v78, v78, v80, s92
    v_mfma_f32_16x16x32_bf16 v[136:139], v[56:59], a[72:75], v[136:139]
    s_add_u32 m0, s9, 16384
    ds_read_b64_tr_b16 v[54:55], v13 offset:45568
    v_fma_f32 v79, v79, v80, s92
    v_mfma_f32_16x16x32_bf16 v[152:155], v[56:59], a[76:79], v[152:155]
    s_waitcnt lgkmcnt(8)
    v_mul_f32 v175, v175, v167
    v_mul_f32 v78, v78, v166
    v_mfma_f32_16x16x32_bf16 v[156:159], v[60:63], a[76:79], v[156:159]
    v_mul_f32 v79, v79, v167
    v_exp_f32_e64 v78, v78
    v_mfma_f32_16x16x32_bf16 v[140:143], v[60:63], a[72:75], v[140:143]
    buffer_load_dwordx4 v16, s[60:63], s7 offen offset:0 lds
    v_mfma_f32_16x16x32_bf16 v[220:223], v[60:63], a[68:71], v[220:223]
    v_exp_f32 v79, v79
    v_mfma_f32_16x16x32_bf16 v[204:207], v[60:63], a[64:67], v[204:207]
    s_waitcnt lgkmcnt(6)
    v_add_f32 v78, 1.0, v78
    v_add_f32 v79, 1.0, v79
    v_mfma_f32_16x16x32_bf16 v[192:195], v[64:67], a[80:83], v[192:195]
    v_rcp_f32_e64 v78, v78
    v_mfma_f32_16x16x32_bf16 v[208:211], v[64:67], a[84:87], v[208:211]
    buffer_load_dwordx4 v17, s[60:63], s7 offen offset:1024 lds
    v_mfma_f32_16x16x32_bf16 v[128:131], v[64:67], a[88:91], v[128:131]
    v_rcp_f32 v79, v79
    v_mfma_f32_16x16x32_bf16 v[144:147], v[64:67], a[92:95], v[144:147]
    s_waitcnt vmcnt(20) lgkmcnt(0)
    s_barrier
    ds_read_b64_tr_b16 v[56:57], v12 offset:49152
    v_mfma_f32_16x16x32_bf16 v[148:151], v[68:71], a[92:95], v[148:151]
    ds_read_b64_tr_b16 v[58:59], v12 offset:49664
    v_mul_f32 v78, v78, v174
    v_mfma_f32_16x16x32_bf16 v[132:135], v[68:71], a[88:91], v[132:135]
    v_mul_f32_e64 v79, v79, v175
    v_mfma_f32_16x16x32_bf16 v[212:215], v[68:71], a[84:87], v[212:215]
    ds_read_b64_tr_b16 v[60:61], v13 offset:49152
    v_cvt_pk_bf16_f32 v163, v78, v79
    v_mfma_f32_16x16x32_bf16 v[196:199], v[68:71], a[80:83], v[196:199]
    ds_read_b64_tr_b16 v[62:63], v13 offset:49664
    v_mfma_f32_16x16x32_bf16 v[200:203], v[48:51], a[80:83], v[200:203]
    buffer_load_dwordx4 v18, s[60:63], s7 offen offset:2048 lds
    v_mfma_f32_16x16x32_bf16 v[216:219], v[48:51], a[84:87], v[216:219]
    ds_read_b64_tr_b16 v[64:65], v12 offset:57344
    v_mfma_f32_16x16x32_bf16 v[136:139], v[48:51], a[88:91], v[136:139]
    ds_read_b64_tr_b16 v[66:67], v12 offset:57856
    v_mfma_f32_16x16x32_bf16 v[152:155], v[48:51], a[92:95], v[152:155]
    buffer_store_dwordx4 v[160:163], v1, s[64:67], s72 offen offset:2048 sc1
    v_mfma_f32_16x16x32_bf16 v[156:159], v[52:55], a[92:95], v[156:159]
    ds_read_b64_tr_b16 v[68:69], v13 offset:57344
    v_mfma_f32_16x16x32_bf16 v[140:143], v[52:55], a[88:91], v[140:143]
    ds_read_b64_tr_b16 v[70:71], v13 offset:57856
    v_mfma_f32_16x16x32_bf16 v[220:223], v[52:55], a[84:87], v[220:223]
    buffer_load_dwordx4 v19, s[60:63], s7 offen offset:3072 lds
    v_mfma_f32_16x16x32_bf16 v[204:207], v[52:55], a[80:83], v[204:207]
    s_waitcnt lgkmcnt(6)
    s_add_u32 s7, s7, 28672
    v_mul_f32 v72, v176, v176
    v_mfma_f32_16x16x32_bf16 v[192:195], v[56:59], a[96:99], v[192:195]
    s_add_u32 m0, s9, 32768
    ds_read_b64_tr_b16 v[48:49], v12 offset:53248
    v_mul_f32_e64 v73, v177, v177
    v_mfma_f32_16x16x32_bf16 v[208:211], v[56:59], a[100:103], v[208:211]
    ds_read_b64_tr_b16 v[50:51], v12 offset:53760
    v_mul_f32_e64 v184, v184, v176
    v_mfma_f32_16x16x32_bf16 v[128:131], v[56:59], a[104:107], v[128:131]
    buffer_load_dwordx4 v16, s[60:63], s7 offen offset:0 lds
    v_mfma_f32_16x16x32_bf16 v[144:147], v[56:59], a[108:111], v[144:147]
    s_waitcnt lgkmcnt(6)
    ds_read_b64_tr_b16 v[52:53], v13 offset:53248
    v_fma_f32 v72, v72, v80, s92
    v_mfma_f32_16x16x32_bf16 v[148:151], v[60:63], a[108:111], v[148:151]
    ds_read_b64_tr_b16 v[54:55], v13 offset:53760
    v_fma_f32 v73, v73, v80, s92
    v_mfma_f32_16x16x32_bf16 v[132:135], v[60:63], a[104:107], v[132:135]
    v_mul_f32 v185, v185, v177
    v_mfma_f32_16x16x32_bf16 v[212:215], v[60:63], a[100:103], v[212:215]
    ds_read_b64_tr_b16 v[56:57], v12 offset:61440
    v_mul_f32_e64 v72, v72, v176
    v_mfma_f32_16x16x32_bf16 v[196:199], v[60:63], a[96:99], v[196:199]
    s_waitcnt lgkmcnt(7)
    ds_read_b64_tr_b16 v[58:59], v12 offset:61952
    v_mul_f32 v73, v73, v177
    v_mfma_f32_16x16x32_bf16 v[200:203], v[64:67], a[96:99], v[200:203]
    buffer_load_dwordx4 v17, s[60:63], s7 offen offset:1024 lds
    v_mfma_f32_16x16x32_bf16 v[216:219], v[64:67], a[100:103], v[216:219]
    ds_read_b64_tr_b16 v[60:61], v13 offset:61440
    v_exp_f32_e64 v72, v72
    v_mfma_f32_16x16x32_bf16 v[136:139], v[64:67], a[104:107], v[136:139]
    ds_read_b64_tr_b16 v[62:63], v13 offset:61952
    v_mfma_f32_16x16x32_bf16 v[152:155], v[64:67], a[108:111], v[152:155]
    s_waitcnt lgkmcnt(8)
    v_exp_f32 v73, v73
    v_mfma_f32_16x16x32_bf16 v[156:159], v[68:71], a[108:111], v[156:159]
    v_add_f32_e64 v72, 1.0, v72
    v_mfma_f32_16x16x32_bf16 v[140:143], v[68:71], a[104:107], v[140:143]
    buffer_load_dwordx4 v18, s[60:63], s7 offen offset:2048 lds
    v_mfma_f32_16x16x32_bf16 v[220:223], v[68:71], a[100:103], v[220:223]
    v_add_f32 v73, 1.0, v73
    v_rcp_f32 v72, v72
    v_mfma_f32_16x16x32_bf16 v[204:207], v[68:71], a[96:99], v[204:207]
    s_waitcnt lgkmcnt(6)
    v_mul_f32 v72, v72, v184
    v_mfma_f32_16x16x32_bf16 v[192:195], v[48:51], a[112:115], v[192:195]
    s_waitcnt vmcnt(8)
    ds_read_b64_tr_b16 a[0:1], v24 offset:0
    v_rcp_f32 v73, v73
    v_mfma_f32_16x16x32_bf16 v[208:211], v[48:51], a[116:119], v[208:211]
    buffer_load_dwordx4 v19, s[60:63], s7 offen offset:3072 lds
    v_mfma_f32_16x16x32_bf16 v[128:131], v[48:51], a[120:123], v[128:131]
    s_add_u32 s7, s7, 28672
    ds_read_b64_tr_b16 a[2:3], v24 offset:2048
    v_mfma_f32_16x16x32_bf16 v[144:147], v[48:51], a[124:127], v[144:147]
    s_waitcnt lgkmcnt(2)
    s_barrier
    ds_read_b64_tr_b16 v[64:65], v14 offset:0
    v_mfma_f32_16x16x32_bf16 v[148:151], v[52:55], a[124:127], v[148:151]
    s_add_u32 m0, s9, 49152
    ds_read_b64_tr_b16 v[66:67], v14 offset:512
    ds_read_b64_tr_b16 a[4:5], v25 offset:0
    v_mfma_f32_16x16x32_bf16 v[132:135], v[52:55], a[120:123], v[132:135]
    ds_read_b64_tr_b16 a[6:7], v25 offset:2048
    v_mul_f32_e64 v73, v73, v185
    v_mfma_f32_16x16x32_bf16 v[212:215], v[52:55], a[116:119], v[212:215]
    ds_read_b64_tr_b16 v[68:69], v15 offset:0
    v_cvt_pk_bf16_f32 v176, v72, v73
    v_mfma_f32_16x16x32_bf16 v[196:199], v[52:55], a[112:115], v[196:199]
    ds_read_b64_tr_b16 v[70:71], v15 offset:512
    ds_read_b64_tr_b16 a[8:9], v26 offset:0
    v_mfma_f32_16x16x32_bf16 v[200:203], v[56:59], a[112:115], v[200:203]
    buffer_load_dwordx4 v16, s[60:63], s7 offen offset:0 lds
    v_mfma_f32_16x16x32_bf16 v[216:219], v[56:59], a[116:119], v[216:219]
    ds_read_b64_tr_b16 v[48:49], v14 offset:8192
    v_mul_f32_e64 v74, v178, v178
    v_mfma_f32_16x16x32_bf16 v[136:139], v[56:59], a[120:123], v[136:139]
    ds_read_b64_tr_b16 v[50:51], v14 offset:8704
    ds_read_b64_tr_b16 a[10:11], v26 offset:2048
    v_mfma_f32_16x16x32_bf16 v[152:155], v[56:59], a[124:127], v[152:155]
    ds_read_b64_tr_b16 a[12:13], v27 offset:0
    v_mul_f32_e64 v75, v179, v179
    v_mfma_f32_16x16x32_bf16 v[156:159], v[60:63], a[124:127], v[156:159]
    ds_read_b64_tr_b16 v[52:53], v15 offset:8192
    v_mul_f32_e64 v186, v186, v178
    v_mfma_f32_16x16x32_bf16 v[140:143], v[60:63], a[120:123], v[140:143]
    ds_read_b64_tr_b16 v[54:55], v15 offset:8704
    ds_read_b64_tr_b16 a[14:15], v27 offset:2048
    v_mfma_f32_16x16x32_bf16 v[220:223], v[60:63], a[116:119], v[220:223]
    buffer_load_dwordx4 v17, s[60:63], s7 offen offset:1024 lds
    v_mfma_f32_16x16x32_bf16 v[204:207], v[60:63], a[112:115], v[204:207]
    s_waitcnt lgkmcnt(12)
    v_fma_f32 v74, v74, v80, s92
    v_fma_f32 v75, v75, v80, s92
    v_mfma_f32_16x16x32_bf16 v[192:195], v[64:67], a[128:131], v[192:195]
    ds_read_b64_tr_b16 v[56:57], v14 offset:4096
    v_mul_f32 v187, v187, v179
    v_mfma_f32_16x16x32_bf16 v[208:211], v[64:67], a[132:135], v[208:211]
    ds_read_b64_tr_b16 v[58:59], v14 offset:4608
    v_mul_f32_e64 v74, v74, v178
    v_mfma_f32_16x16x32_bf16 v[128:131], v[64:67], a[136:139], v[128:131]
    buffer_load_dwordx4 v18, s[60:63], s7 offen offset:2048 lds
    v_mfma_f32_16x16x32_bf16 v[144:147], v[64:67], a[140:143], v[144:147]
    s_waitcnt lgkmcnt(10)
    ds_read_b64_tr_b16 v[60:61], v15 offset:4096
    v_mul_f32 v75, v75, v179
    v_mfma_f32_16x16x32_bf16 v[148:151], v[68:71], a[140:143], v[148:151]
    ds_read_b64_tr_b16 v[62:63], v15 offset:4608
    v_exp_f32_e64 v74, v74
    v_mfma_f32_16x16x32_bf16 v[132:135], v[68:71], a[136:139], v[132:135]
    v_exp_f32 v75, v75
    v_mfma_f32_16x16x32_bf16 v[212:215], v[68:71], a[132:135], v[212:215]
    ds_read_b64_tr_b16 v[64:65], v14 offset:12288
    v_add_f32 v74, 1.0, v74
    v_mfma_f32_16x16x32_bf16 v[196:199], v[68:71], a[128:131], v[196:199]
    s_waitcnt lgkmcnt(10)
    ds_read_b64_tr_b16 v[66:67], v14 offset:12800
    v_add_f32 v75, 1.0, v75
    v_mfma_f32_16x16x32_bf16 v[200:203], v[48:51], a[128:131], v[200:203]
    buffer_load_dwordx4 v19, s[60:63], s7 offen offset:3072 lds
    v_mfma_f32_16x16x32_bf16 v[216:219], v[48:51], a[132:135], v[216:219]
    s_add_u32 s7, s7, 28672
    ds_read_b64_tr_b16 v[68:69], v15 offset:12288
    v_rcp_f32 v74, v74
    v_mfma_f32_16x16x32_bf16 v[136:139], v[48:51], a[136:139], v[136:139]
    s_add_u32 m0, s9, 0
    ds_read_b64_tr_b16 v[70:71], v15 offset:12800
    v_rcp_f32_e64 v75, v75
    v_mfma_f32_16x16x32_bf16 v[152:155], v[48:51], a[140:143], v[152:155]
    s_waitcnt lgkmcnt(9)
    v_mul_f32 v74, v74, v186
    v_mfma_f32_16x16x32_bf16 v[156:159], v[52:55], a[140:143], v[156:159]
    v_mul_f32_e64 v75, v75, v187
    v_mfma_f32_16x16x32_bf16 v[140:143], v[52:55], a[136:139], v[140:143]
    s_waitcnt lgkmcnt(8)
    buffer_load_dwordx4 v16, s[60:63], s7 offen offset:0 lds
    v_mfma_f32_16x16x32_bf16 v[220:223], v[52:55], a[132:135], v[220:223]
    v_cvt_pk_bf16_f32 v177, v74, v75
    v_mul_f32 v76, v180, v180
    v_mfma_f32_16x16x32_bf16 v[204:207], v[52:55], a[128:131], v[204:207]
    s_waitcnt lgkmcnt(6)
    v_mul_f32 v77, v181, v181
    v_mfma_f32_16x16x32_bf16 v[192:195], v[56:59], a[144:147], v[192:195]
    s_waitcnt vmcnt(9)
    ds_read_b64_tr_b16 a[16:17], v24 offset:16384
    v_mul_f32 v188, v188, v180
    v_mfma_f32_16x16x32_bf16 v[208:211], v[56:59], a[148:151], v[208:211]
    buffer_load_dwordx4 v17, s[60:63], s7 offen offset:1024 lds
    v_mfma_f32_16x16x32_bf16 v[128:131], v[56:59], a[152:155], v[128:131]
    ds_read_b64_tr_b16 a[18:19], v24 offset:18432
    v_fma_f32 v76, v76, v80, s92
    v_mfma_f32_16x16x32_bf16 v[144:147], v[56:59], a[156:159], v[144:147]
    s_waitcnt lgkmcnt(2)
    s_barrier
    ds_read_b64_tr_b16 v[48:49], v14 offset:16384
    v_fma_f32 v77, v77, v80, s92
    v_mfma_f32_16x16x32_bf16 v[148:151], v[60:63], a[156:159], v[148:151]
    ds_read_b64_tr_b16 v[50:51], v14 offset:16896
    ds_read_b64_tr_b16 a[20:21], v25 offset:16384
    v_mfma_f32_16x16x32_bf16 v[132:135], v[60:63], a[152:155], v[132:135]
    ds_read_b64_tr_b16 a[22:23], v25 offset:18432
    v_mul_f32 v189, v189, v181
    v_mfma_f32_16x16x32_bf16 v[212:215], v[60:63], a[148:151], v[212:215]
    ds_read_b64_tr_b16 v[52:53], v15 offset:16384
    v_mul_f32 v76, v76, v180
    v_mfma_f32_16x16x32_bf16 v[196:199], v[60:63], a[144:147], v[196:199]
    ds_read_b64_tr_b16 v[54:55], v15 offset:16896
    ds_read_b64_tr_b16 a[24:25], v26 offset:16384
    v_mfma_f32_16x16x32_bf16 v[200:203], v[64:67], a[144:147], v[200:203]
    buffer_load_dwordx4 v18, s[60:63], s7 offen offset:2048 lds
    v_mfma_f32_16x16x32_bf16 v[216:219], v[64:67], a[148:151], v[216:219]
    ds_read_b64_tr_b16 v[56:57], v14 offset:24576
    v_mul_f32_e64 v77, v77, v181
    v_mfma_f32_16x16x32_bf16 v[136:139], v[64:67], a[152:155], v[136:139]
    ds_read_b64_tr_b16 v[58:59], v14 offset:25088
    ds_read_b64_tr_b16 a[26:27], v26 offset:18432
    v_mfma_f32_16x16x32_bf16 v[152:155], v[64:67], a[156:159], v[152:155]
    ds_read_b64_tr_b16 a[28:29], v27 offset:16384
    v_exp_f32 v76, v76
    v_mfma_f32_16x16x32_bf16 v[156:159], v[68:71], a[156:159], v[156:159]
    ds_read_b64_tr_b16 v[60:61], v15 offset:24576
    v_exp_f32 v77, v77
    v_mfma_f32_16x16x32_bf16 v[140:143], v[68:71], a[152:155], v[140:143]
    ds_read_b64_tr_b16 v[62:63], v15 offset:25088
    ds_read_b64_tr_b16 a[30:31], v27 offset:18432
    v_mfma_f32_16x16x32_bf16 v[220:223], v[68:71], a[148:151], v[220:223]
    buffer_load_dwordx4 v19, s[60:63], s7 offen offset:3072 lds
    v_mfma_f32_16x16x32_bf16 v[204:207], v[68:71], a[144:147], v[204:207]
    s_waitcnt lgkmcnt(12)
    s_add_u32 s7, s7, 28672
    v_add_f32 v76, 1.0, v76
    v_add_f32_e64 v77, 1.0, v77
    v_mfma_f32_16x16x32_bf16 v[192:195], v[48:51], a[160:163], v[192:195]
    s_add_u32 m0, s9, 65536
    ds_read_b64_tr_b16 v[64:65], v14 offset:20480
    s_waitcnt vmcnt(8)
    ds_read_b64_tr_b16 a[32:33], v24 offset:32768
    v_mfma_f32_16x16x32_bf16 v[208:211], v[48:51], a[164:167], v[208:211]
    ds_read_b64_tr_b16 v[66:67], v14 offset:20992
    v_rcp_f32 v76, v76
    v_mfma_f32_16x16x32_bf16 v[128:131], v[48:51], a[168:171], v[128:131]
    buffer_load_dwordx4 v16, s[60:63], s7 offen offset:0 lds
    v_mfma_f32_16x16x32_bf16 v[144:147], v[48:51], a[172:175], v[144:147]
    s_waitcnt lgkmcnt(11)
    ds_read_b64_tr_b16 v[68:69], v15 offset:20480
    ds_read_b64_tr_b16 a[34:35], v24 offset:34816
    v_mfma_f32_16x16x32_bf16 v[148:151], v[52:55], a[172:175], v[148:151]
    ds_read_b64_tr_b16 v[70:71], v15 offset:20992
    v_rcp_f32 v77, v77
    v_mfma_f32_16x16x32_bf16 v[132:135], v[52:55], a[168:171], v[132:135]
    ds_read_b64_tr_b16 a[36:37], v25 offset:32768
    v_mul_f32_e64 v76, v76, v188
    v_mfma_f32_16x16x32_bf16 v[212:215], v[52:55], a[164:167], v[212:215]
    ds_read_b64_tr_b16 v[48:49], v14 offset:28672
    ds_read_b64_tr_b16 a[38:39], v25 offset:34816
    v_mfma_f32_16x16x32_bf16 v[196:199], v[52:55], a[160:163], v[196:199]
    s_waitcnt lgkmcnt(14)
    ds_read_b64_tr_b16 v[50:51], v14 offset:29184
    v_mul_f32 v77, v77, v189
    v_mfma_f32_16x16x32_bf16 v[200:203], v[56:59], a[160:163], v[200:203]
    buffer_load_dwordx4 v17, s[60:63], s7 offen offset:1024 lds
    v_mfma_f32_16x16x32_bf16 v[216:219], v[56:59], a[164:167], v[216:219]
    ds_read_b64_tr_b16 v[52:53], v15 offset:28672
    ds_read_b64_tr_b16 a[40:41], v26 offset:32768
    v_mfma_f32_16x16x32_bf16 v[136:139], v[56:59], a[168:171], v[136:139]
    ds_read_b64_tr_b16 v[54:55], v15 offset:29184
    v_cvt_pk_bf16_f32 v178, v76, v77
    v_mfma_f32_16x16x32_bf16 v[152:155], v[56:59], a[172:175], v[152:155]
    s_waitcnt lgkmcnt(14)
    ds_read_b64_tr_b16 a[42:43], v26 offset:34816
    v_mul_f32 v78, v182, v182
    v_mfma_f32_16x16x32_bf16 v[156:159], v[60:63], a[172:175], v[156:159]
    ds_read_b64_tr_b16 a[44:45], v27 offset:32768
    v_mul_f32_e64 v79, v183, v183
    v_mfma_f32_16x16x32_bf16 v[140:143], v[60:63], a[168:171], v[140:143]
    buffer_load_dwordx4 v18, s[60:63], s7 offen offset:2048 lds
    v_mfma_f32_16x16x32_bf16 v[220:223], v[60:63], a[164:167], v[220:223]
    ds_read_b64_tr_b16 a[46:47], v27 offset:34816
    v_mul_f32 v190, v190, v182
    v_mfma_f32_16x16x32_bf16 v[204:207], v[60:63], a[160:163], v[204:207]
    s_waitcnt lgkmcnt(13)
    v_fma_f32 v78, v78, v80, s92
    v_fma_f32 v79, v79, v80, s92
    v_mfma_f32_16x16x32_bf16 v[192:195], v[64:67], a[176:179], v[192:195]
    s_waitcnt vmcnt(7)
    ds_read_b64_tr_b16 a[48:49], v24 offset:49152
    v_mul_f32 v191, v191, v183
    v_mfma_f32_16x16x32_bf16 v[208:211], v[64:67], a[180:183], v[208:211]
    buffer_load_dwordx4 v19, s[60:63], s7 offen offset:3072 lds
    v_mfma_f32_16x16x32_bf16 v[128:131], v[64:67], a[184:187], v[128:131]
    s_add_u32 s7, s7, 28672
    ds_read_b64_tr_b16 a[50:51], v24 offset:51200
    v_mul_f32 v78, v78, v182
    v_mfma_f32_16x16x32_bf16 v[144:147], v[64:67], a[188:191], v[144:147]
    s_waitcnt lgkmcnt(5)
    s_barrier
    ds_read_b64_tr_b16 v[56:57], v14 offset:32768
    v_mul_f32 v79, v79, v183
    v_mfma_f32_16x16x32_bf16 v[148:151], v[68:71], a[188:191], v[148:151]
    s_add_u32 m0, s9, 16384
    ds_read_b64_tr_b16 v[58:59], v14 offset:33280
    ds_read_b64_tr_b16 a[52:53], v25 offset:49152
    v_mfma_f32_16x16x32_bf16 v[132:135], v[68:71], a[184:187], v[132:135]
    ds_read_b64_tr_b16 a[54:55], v25 offset:51200
    v_exp_f32 v78, v78
    v_mfma_f32_16x16x32_bf16 v[212:215], v[68:71], a[180:183], v[212:215]
    ds_read_b64_tr_b16 v[60:61], v15 offset:32768
    v_exp_f32 v79, v79
    v_mfma_f32_16x16x32_bf16 v[196:199], v[68:71], a[176:179], v[196:199]
    ds_read_b64_tr_b16 v[62:63], v15 offset:33280
    ds_read_b64_tr_b16 a[56:57], v26 offset:49152
    v_mfma_f32_16x16x32_bf16 v[200:203], v[48:51], a[176:179], v[200:203]
    s_mov_b32 s99, 0
    buffer_load_dwordx4 v16, s[60:63], s7 offen offset:0 lds
    v_mfma_f32_16x16x32_bf16 v[216:219], v[48:51], a[180:183], v[216:219]
    ds_read_b64_tr_b16 v[64:65], v14 offset:40960
    v_add_f32 v78, 1.0, v78
    v_mfma_f32_16x16x32_bf16 v[136:139], v[48:51], a[184:187], v[136:139]
    ds_read_b64_tr_b16 v[66:67], v14 offset:41472
    ds_read_b64_tr_b16 a[58:59], v26 offset:51200
    v_mfma_f32_16x16x32_bf16 v[152:155], v[48:51], a[188:191], v[152:155]
    ds_read_b64_tr_b16 a[60:61], v27 offset:49152
    v_add_f32 v79, 1.0, v79
    v_mfma_f32_16x16x32_bf16 v[156:159], v[52:55], a[188:191], v[156:159]
    ds_read_b64_tr_b16 v[68:69], v15 offset:40960
    v_rcp_f32 v78, v78
    v_mfma_f32_16x16x32_bf16 v[140:143], v[52:55], a[184:187], v[140:143]
    ds_read_b64_tr_b16 v[70:71], v15 offset:41472
    ds_read_b64_tr_b16 a[62:63], v27 offset:51200
    v_mfma_f32_16x16x32_bf16 v[220:223], v[52:55], a[180:183], v[220:223]
    buffer_load_dwordx4 v17, s[60:63], s7 offen offset:1024 lds
    v_mfma_f32_16x16x32_bf16 v[204:207], v[52:55], a[176:179], v[204:207]
    s_waitcnt lgkmcnt(12)
    v_rcp_f32 v79, v79
    v_mfma_f32_16x16x32_bf16 v[192:195], v[56:59], a[192:195], v[192:195]
    ds_read_b64_tr_b16 v[48:49], v14 offset:36864
    v_mul_f32 v78, v78, v190
    v_mfma_f32_16x16x32_bf16 v[208:211], v[56:59], a[196:199], v[208:211]
    ds_read_b64_tr_b16 v[50:51], v14 offset:37376
    v_mul_f32 v79, v79, v191
    v_mfma_f32_16x16x32_bf16 v[128:131], v[56:59], a[200:203], v[128:131]
    v_cvt_pk_bf16_f32 v179, v78, v79
    v_lshrrev_b32 v8, 16, v20
    v_mfma_f32_16x16x32_bf16 v[144:147], v[56:59], a[204:207], v[144:147]
    s_waitcnt lgkmcnt(10)
    buffer_store_dwordx4 v[176:179], v1, s[64:67], s72 offen offset:3072 sc1
    v_mfma_f32_16x16x32_bf16 v[148:151], v[60:63], a[204:207], v[148:151]
    s_load_dword s99, s[46:47], 128
    buffer_load_dwordx4 v18, s[60:63], s7 offen offset:2048 lds
    v_mfma_f32_16x16x32_bf16 v[132:135], v[60:63], a[200:203], v[132:135]
    ds_read_b64_tr_b16 v[52:53], v15 offset:36864
    ds_read_b64_tr_b16 v[54:55], v15 offset:37376
    v_mfma_f32_16x16x32_bf16 v[212:215], v[60:63], a[196:199], v[212:215]
    ds_read_b64_tr_b16 v[56:57], v14 offset:45056
    v_and_b32 v20, 0xffff, v20
    v_mfma_f32_16x16x32_bf16 v[196:199], v[60:63], a[192:195], v[196:199]
    s_waitcnt lgkmcnt(10)
    ds_read_b64_tr_b16 v[58:59], v14 offset:45568
    v_lshrrev_b32 v9, 16, v21
    v_mfma_f32_16x16x32_bf16 v[200:203], v[64:67], a[192:195], v[200:203]
    buffer_load_dwordx4 v19, s[60:63], s7 offen offset:3072 lds
    v_mfma_f32_16x16x32_bf16 v[216:219], v[64:67], a[196:199], v[216:219]
    s_add_u32 s7, s7, 630784
    ds_read_b64_tr_b16 v[60:61], v15 offset:45056
    v_mfma_f32_16x16x32_bf16 v[136:139], v[64:67], a[200:203], v[136:139]
    s_add_u32 m0, s9, 81920
    ds_read_b64_tr_b16 v[62:63], v15 offset:45568
    v_and_b32 v21, 0xffff, v21
    v_mfma_f32_16x16x32_bf16 v[152:155], v[64:67], a[204:207], v[152:155]
    s_waitcnt lgkmcnt(9)
    v_lshrrev_b32 v10, 16, v22
    v_mfma_f32_16x16x32_bf16 v[156:159], v[68:71], a[204:207], v[156:159]
    v_lshlrev_b32_e64 v12, 16, v7
    v_mfma_f32_16x16x32_bf16 v[140:143], v[68:71], a[200:203], v[140:143]
    buffer_load_dwordx4 v16, s[60:63], s7 offen offset:0 lds
    v_mfma_f32_16x16x32_bf16 v[220:223], v[68:71], a[196:199], v[220:223]
    v_and_b32 v13, 0xffff0000, v7
    v_mfma_f32_16x16x32_bf16 v[204:207], v[68:71], a[192:195], v[204:207]
    s_waitcnt lgkmcnt(6)
    v_and_b32 v22, 0xffff, v22
    v_mfma_f32_16x16x32_bf16 v[192:195], v[48:51], a[208:211], v[192:195]
    s_waitcnt vmcnt(10)
    ds_read_b64_tr_b16 a[64:65], v24 offset:0
    v_mfma_f32_16x16x32_bf16 v[208:211], v[48:51], a[212:215], v[208:211]
    buffer_load_dwordx4 v17, s[60:63], s7 offen offset:1024 lds
    v_mfma_f32_16x16x32_bf16 v[128:131], v[48:51], a[216:219], v[128:131]
    ds_read_b64_tr_b16 a[66:67], v24 offset:2048
    v_mfma_f32_16x16x32_bf16 v[144:147], v[48:51], a[220:223], v[144:147]
    s_waitcnt lgkmcnt(2)
    s_barrier
    ds_read_b64_tr_b16 a[68:69], v25 offset:0
    v_mfma_f32_16x16x32_bf16 v[148:151], v[52:55], a[220:223], v[148:151]
    ds_read_b128 v[160:163], v42 offset:0
    v_lshrrev_b32_e64 v11, 16, v23
    v_mfma_f32_16x16x32_bf16 v[132:135], v[52:55], a[216:219], v[132:135]
    ds_read_b128 v[164:167], v42 offset:64
    ds_read_b64_tr_b16 a[70:71], v25 offset:2048
    v_mfma_f32_16x16x32_bf16 v[212:215], v[52:55], a[212:215], v[212:215]
    ds_read_b128 v[168:171], v42 offset:128
    v_mfma_f32_16x16x32_bf16 v[196:199], v[52:55], a[208:211], v[196:199]
    ds_read_b128 v[172:175], v42 offset:192
    ds_read_b64_tr_b16 a[72:73], v26 offset:0
    v_mfma_f32_16x16x32_bf16 v[200:203], v[56:59], a[208:211], v[200:203]
    buffer_load_dwordx4 v18, s[60:63], s7 offen offset:2048 lds
    v_mfma_f32_16x16x32_bf16 v[216:219], v[56:59], a[212:215], v[216:219]
    ds_read_b128 v[176:179], v42 offset:256
    v_mfma_f32_16x16x32_bf16 v[136:139], v[56:59], a[216:219], v[136:139]
    ds_read_b64_tr_b16 a[74:75], v26 offset:2048
    v_and_b32 v23, 0xffff, v23
    v_mfma_f32_16x16x32_bf16 v[152:155], v[56:59], a[220:223], v[152:155]
    ds_read_b128 v[180:183], v42 offset:320
    ds_read_b64_tr_b16 a[76:77], v27 offset:0
    v_mfma_f32_16x16x32_bf16 v[156:159], v[60:63], a[220:223], v[156:159]
    ds_read_b128 v[184:187], v42 offset:384
    v_mfma_f32_16x16x32_bf16 v[140:143], v[60:63], a[216:219], v[140:143]
    ds_read_b128 v[188:191], v42 offset:448
    ds_read_b64_tr_b16 a[78:79], v27 offset:2048
    v_mfma_f32_16x16x32_bf16 v[220:223], v[60:63], a[212:215], v[220:223]
    buffer_load_dwordx4 v19, s[60:63], s7 offen offset:3072 lds
    v_mfma_f32_16x16x32_bf16 v[204:207], v[60:63], a[208:211], v[204:207]
    s_add_u32 s7, s7, 28672
    s_add_u32 s72, s72, 114688
    s_cmp_lt_u32 s99, 32
    s_cbranch_scc1 L_slow0
L_back0:
    s_lshl_b32 s0, s3, 10
    s_add_u32 m0, s0, 34976
    s_nop 0
    buffer_load_dwordx4 v32, s[64:67], s78 offen sc1 lds
    s_add_u32 m0, s0, 39136
    s_nop 0
    buffer_load_dwordx4 v32, s[64:67], s78 offen offset:128 sc1 lds
    buffer_load_dword v7, v6, s[64:67], s80 offen offset:64 sc1
    s_nop 0
    buffer_load_dword v6, v6, s[64:67], s80 offen sc1
    v_pk_mul_f32 v[72:73], v[192:193], v[192:193]
    v_pk_mul_f32 v[200:201], v[200:201], v[192:193]
    s_add_u32 m0, s9, 32768
    v_pk_fma_f32 v[72:73], v[72:73], v[80:81], s[92:93]
    v_pk_mul_f32 v[74:75], v[194:195], v[194:195]
    v_pk_mul_f32 v[202:203], v[202:203], v[194:195]
    v_pk_mul_f32 v[72:73], v[72:73], v[192:193]
    v_pk_fma_f32 v[74:75], v[74:75], v[80:81], s[92:93]
    v_pk_mul_f32 v[76:77], v[196:197], v[196:197]
    v_exp_f32 v72, v72
    v_exp_f32 v73, v73
    v_pk_mul_f32 v[74:75], v[74:75], v[194:195]
    v_pk_mul_f32 v[204:205], v[204:205], v[196:197]
    v_pk_add_f32 v[72:73], v[72:73], s[94:95]
    v_exp_f32 v74, v74
    v_rcp_f32 v72, v72
    v_rcp_f32 v73, v73
    v_exp_f32 v75, v75
    v_pk_mul_f32 v[72:73], v[72:73], v[200:201]
    v_pk_fma_f32 v[76:77], v[76:77], v[80:81], s[92:93]
    v_pk_add_f32 v[74:75], v[74:75], s[94:95]
    v_cvt_pk_bf16_f32 v192, v72, v73
    v_pk_mul_f32 v[76:77], v[76:77], v[196:197]
    v_rcp_f32 v74, v74
    v_rcp_f32 v75, v75
    v_exp_f32 v76, v76
    v_pk_mul_f32 v[74:75], v[74:75], v[202:203]
    v_exp_f32 v77, v77
    v_cvt_pk_bf16_f32 v193, v74, v75
    v_pk_mul_f32 v[78:79], v[198:199], v[198:199]
    v_pk_add_f32 v[76:77], v[76:77], s[94:95]
    v_pk_mul_f32 v[206:207], v[206:207], v[198:199]
    v_pk_fma_f32 v[78:79], v[78:79], v[80:81], s[92:93]
    v_rcp_f32 v76, v76
    v_rcp_f32 v77, v77
    v_pk_mul_f32 v[78:79], v[78:79], v[198:199]
    v_pk_mul_f32 v[72:73], v[208:209], v[208:209]
    v_pk_mul_f32 v[76:77], v[76:77], v[204:205]
    v_exp_f32 v78, v78
    v_cvt_pk_bf16_f32 v194, v76, v77
    v_exp_f32 v79, v79
    v_pk_mul_f32 v[216:217], v[216:217], v[208:209]
    v_pk_fma_f32 v[72:73], v[72:73], v[80:81], s[92:93]
    v_pk_add_f32 v[78:79], v[78:79], s[94:95]
    v_pk_mul_f32 v[72:73], v[72:73], v[208:209]
    v_rcp_f32 v78, v78
    v_rcp_f32 v79, v79
    v_exp_f32 v72, v72
    v_pk_mul_f32 v[78:79], v[78:79], v[206:207]
    v_exp_f32 v73, v73
    v_cvt_pk_bf16_f32 v195, v78, v79
    v_pk_mul_f32 v[74:75], v[210:211], v[210:211]
    v_pk_add_f32 v[72:73], v[72:73], s[94:95]
    v_pk_mul_f32 v[218:219], v[218:219], v[210:211]
    v_pk_fma_f32 v[74:75], v[74:75], v[80:81], s[92:93]
    v_rcp_f32 v72, v72
    v_rcp_f32 v73, v73
    v_pk_mul_f32 v[74:75], v[74:75], v[210:211]
    v_pk_mul_f32 v[72:73], v[72:73], v[216:217]
    v_exp_f32 v74, v74
    v_cvt_pk_bf16_f32 v208, v72, v73
    v_exp_f32 v75, v75
    s_nop 0
    v_pk_add_f32 v[74:75], v[74:75], s[94:95]
    buffer_load_dwordx4 v16, s[60:63], s7 offen offset:0 lds
    buffer_load_dwordx4 v17, s[60:63], s7 offen offset:1024 lds
    s_waitcnt vmcnt(12)
    s_atomic_add s51, s[48:49], s74
    buffer_load_dwordx4 v18, s[60:63], s7 offen offset:2048 lds
    buffer_load_dwordx4 v19, s[60:63], s7 offen offset:3072 lds
    ds_read_b64_tr_b16 a[80:81], v28 offset:0
    ds_read_b64_tr_b16 a[82:83], v28 offset:2048
    ds_read_b64_tr_b16 a[84:85], v29 offset:0
    ds_read_b64_tr_b16 a[86:87], v29 offset:2048
    ds_read_b64_tr_b16 a[88:89], v30 offset:0
    ds_read_b64_tr_b16 a[90:91], v30 offset:2048
    ds_read_b64_tr_b16 a[92:93], v31 offset:0
    ds_read_b64_tr_b16 a[94:95], v31 offset:2048
    s_add_u32 s74, s74, 32768
    s_add_u32 s7, s7, 28672
    s_add_u32 m0, s9, 49152
    s_nop 0
    buffer_load_dwordx4 v16, s[60:63], s7 offen offset:0 lds
    s_nop 0
    buffer_load_dwordx4 v17, s[60:63], s7 offen offset:1024 lds
L_st4:
    s_cbranch_execz L_hopret
    buffer_load_dwordx4 v18, s[60:63], s7 offen offset:2048 lds
    buffer_load_dwordx4 v19, s[60:63], s7 offen offset:3072 lds
    s_waitcnt vmcnt(16)
    ds_read_b64_tr_b16 a[96:97], v24 offset:16384
    ds_read_b64_tr_b16 a[98:99], v24 offset:18432
    ds_read_b64_tr_b16 a[100:101], v25 offset:16384
    ds_read_b64_tr_b16 a[102:103], v25 offset:18432
    ds_read_b64_tr_b16 a[104:105], v26 offset:16384
    ds_read_b64_tr_b16 a[106:107], v26 offset:18432
    ds_read_b64_tr_b16 a[108:109], v27 offset:16384
    ds_read_b64_tr_b16 a[110:111], v27 offset:18432
    s_add_u32 s7, s7, 28672
    v_rcp_f32 v74, v74
    v_rcp_f32 v75, v75
    v_pk_mul_f32 v[76:77], v[212:213], v[212:213]
    v_pk_mul_f32 v[220:221], v[220:221], v[212:213]
    v_pk_mul_f32 v[74:75], v[74:75], v[218:219]
    v_pk_fma_f32 v[76:77], v[76:77], v[80:81], s[92:93]
    s_add_u32 m0, s9, 98304
    v_cvt_pk_bf16_f32 v209, v74, v75
    v_pk_mul_f32 v[76:77], v[76:77], v[212:213]
    v_pk_mul_f32 v[78:79], v[214:215], v[214:215]
    v_pk_mul_f32 v[222:223], v[222:223], v[214:215]
    v_exp_f32 v76, v76
    v_exp_f32 v77, v77
    v_pk_fma_f32 v[78:79], v[78:79], v[80:81], s[92:93]
    v_pk_mul_f32 v[72:73], v[128:129], v[128:129]
    v_pk_add_f32 v[76:77], v[76:77], s[94:95]
    v_pk_mul_f32 v[78:79], v[78:79], v[214:215]
    v_pk_mul_f32 v[136:137], v[136:137], v[128:129]
    v_rcp_f32 v76, v76
    v_rcp_f32 v77, v77
    v_exp_f32 v78, v78
    v_pk_mul_f32 v[76:77], v[76:77], v[220:221]
    v_exp_f32 v79, v79
    v_cvt_pk_bf16_f32 v210, v76, v77
    v_pk_fma_f32 v[72:73], v[72:73], v[80:81], s[92:93]
    v_pk_add_f32 v[78:79], v[78:79], s[94:95]
    v_pk_mul_f32 v[74:75], v[130:131], v[130:131]
    v_pk_mul_f32 v[72:73], v[72:73], v[128:129]
    v_rcp_f32 v78, v78
    v_rcp_f32 v79, v79
    v_exp_f32 v72, v72
    v_pk_mul_f32 v[78:79], v[78:79], v[222:223]
    v_exp_f32 v73, v73
    v_cvt_pk_bf16_f32 v211, v78, v79
    v_pk_mul_f32 v[138:139], v[138:139], v[130:131]
    v_pk_add_f32 v[72:73], v[72:73], s[94:95]
    v_pk_fma_f32 v[74:75], v[74:75], v[80:81], s[92:93]
    v_pk_mul_f32 v[76:77], v[132:133], v[132:133]
    v_rcp_f32 v72, v72
    v_rcp_f32 v73, v73
    v_pk_mul_f32 v[74:75], v[74:75], v[130:131]
    v_pk_mul_f32 v[140:141], v[140:141], v[132:133]
    v_pk_mul_f32 v[72:73], v[72:73], v[136:137]
    v_exp_f32 v74, v74
    v_cvt_pk_bf16_f32 v128, v72, v73
    v_exp_f32 v75, v75
    v_pk_fma_f32 v[76:77], v[76:77], v[80:81], s[92:93]
    v_pk_mul_f32 v[78:79], v[134:135], v[134:135]
    v_pk_add_f32 v[74:75], v[74:75], s[94:95]
    v_pk_mul_f32 v[76:77], v[76:77], v[132:133]
    v_pk_mul_f32 v[142:143], v[142:143], v[134:135]
    v_rcp_f32 v74, v74
    v_rcp_f32 v75, v75
    v_exp_f32 v76, v76
    v_pk_mul_f32 v[74:75], v[74:75], v[138:139]
    v_exp_f32 v77, v77
    v_cvt_pk_bf16_f32 v129, v74, v75
    v_pk_fma_f32 v[78:79], v[78:79], v[80:81], s[92:93]
    v_pk_add_f32 v[76:77], v[76:77], s[94:95]
    v_pk_mul_f32 v[72:73], v[144:145], v[144:145]
    v_pk_mul_f32 v[78:79], v[78:79], v[134:135]
    v_rcp_f32 v76, v76
    v_rcp_f32 v77, v77
    v_exp_f32 v78, v78
    v_pk_mul_f32 v[76:77], v[76:77], v[140:141]
    v_exp_f32 v79, v79
    v_cvt_pk_bf16_f32 v130, v76, v77
    v_pk_mul_f32 v[152:153], v[152:153], v[144:145]
    v_pk_add_f32 v[78:79], v[78:79], s[94:95]
    v_pk_fma_f32 v[72:73], v[72:73], v[80:81], s[92:93]
    v_pk_mul_f32 v[74:75], v[146:147], v[146:147]
    v_rcp_f32 v78, v78
    v_rcp_f32 v79, v79
    v_pk_mul_f32 v[72:73], v[72:73], v[144:145]
    v_pk_mul_f32 v[154:155], v[154:155], v[146:147]
    v_pk_mul_f32 v[78:79], v[78:79], v[142:143]
    v_exp_f32 v72, v72
    v_cvt_pk_bf16_f32 v131, v78, v79
    v_exp_f32 v73, v73
    v_pk_fma_f32 v[74:75], v[74:75], v[80:81], s[92:93]
    v_pk_mul_f32 v[76:77], v[148:149], v[148:149]
    v_pk_add_f32 v[72:73], v[72:73], s[94:95]
    v_pk_mul_f32 v[74:75], v[74:75], v[146:147]
    v_pk_mul_f32 v[156:157], v[156:157], v[148:149]
    v_rcp_f32 v72, v72
    v_rcp_f32 v73, v73
    v_exp_f32 v74, v74
    v_pk_mul_f32 v[72:73], v[72:73], v[152:153]
    v_exp_f32 v75, v75
    v_cvt_pk_bf16_f32 v144, v72, v73
    v_pk_fma_f32 v[76:77], v[76:77], v[80:81], s[92:93]
    v_pk_add_f32 v[74:75], v[74:75], s[94:95]
    v_pk_mul_f32 v[78:79], v[150:151], v[150:151]
    v_pk_mul_f32 v[76:77], v[76:77], v[148:149]
    v_rcp_f32 v74, v74
    v_rcp_f32 v75, v75
    v_exp_f32 v76, v76
    v_pk_mul_f32 v[74:75], v[74:75], v[154:155]
    v_exp_f32 v77, v77
    v_cvt_pk_bf16_f32 v145, v74, v75
    v_pk_mul_f32 v[158:159], v[158:159], v[150:151]
    v_pk_add_f32 v[76:77], v[76:77], s[94:95]
    v_pk_fma_f32 v[78:79], v[78:79], v[80:81], s[92:93]
    v_rcp_f32 v76, v76
    v_rcp_f32 v77, v77
    v_pk_mul_f32 v[78:79], v[78:79], v[150:151]
    v_pk_mul_f32 v[76:77], v[76:77], v[156:157]
    v_exp_f32 v78, v78
    v_cvt_pk_bf16_f32 v146, v76, v77
    v_exp_f32_e64 v79, v79
    s_nop 0
    v_pk_add_f32 v[78:79], v[78:79], s[94:95]
    v_rcp_f32 v78, v78
    v_rcp_f32_e64 v79, v79
    s_nop 0
    v_pk_mul_f32 v[78:79], v[78:79], v[158:159]
    v_cvt_pk_bf16_f32 v147, v78, v79
    buffer_load_dwordx4 v16, s[60:63], s7 offen offset:0 lds
    buffer_load_dwordx4 v17, s[60:63], s7 offen offset:1024 lds
    buffer_store_dwordx4 v[192:195], v1, s[64:67], s72 offen offset:0 sc1
    buffer_load_dwordx4 v18, s[60:63], s7 offen offset:2048 lds
    buffer_load_dwordx4 v19, s[60:63], s7 offen offset:3072 lds
    buffer_store_dwordx4 v[208:211], v1, s[64:67], s72 offen offset:1024 sc1
    buffer_store_dwordx4 v[128:131], v1, s[64:67], s72 offen offset:2048 sc1
    buffer_store_dwordx4 v[144:147], v1, s[64:67], s72 offen offset:3072 sc1
    s_add_u32 s7, s7, 28672
    s_mov_b32 m0, s84
    s_nop 0
    ds_write_addtid_b32 v118 offset:0
    ds_write_addtid_b32 v119 offset:256
    ds_write_addtid_b32 v120 offset:544
    ds_write_addtid_b32 v121 offset:800
    ds_write_addtid_b32 v122 offset:1088
    ds_write_addtid_b32 v123 offset:1344
    ds_write_addtid_b32 v124 offset:1632
    ds_write_addtid_b32 v125 offset:1888
    ds_write_addtid_b32 v126 offset:2176
    ds_write_addtid_b32 v127 offset:2432
    ds_read_b128 v[128:131], v42 offset:0
    ds_read_b128 v[132:135], v42 offset:64
    ds_read_b128 v[136:139], v42 offset:128
    ds_read_b128 v[140:143], v42 offset:192
    ds_read_b128 v[144:147], v42 offset:256
    ds_read_b128 v[148:151], v42 offset:320
    ds_read_b128 v[152:155], v42 offset:384
    ds_read_b128 v[156:159], v42 offset:448
    ds_write_addtid_b32 v86 offset:0
    ds_write_addtid_b32 v87 offset:256
    ds_write_addtid_b32 v88 offset:544
    ds_write_addtid_b32 v89 offset:800
    ds_write_addtid_b32 v90 offset:1088
    ds_write_addtid_b32 v91 offset:1344
    ds_write_addtid_b32 v92 offset:1632
    ds_write_addtid_b32 v93 offset:1888
    ds_write_addtid_b32 v94 offset:2176
    ds_write_addtid_b32 v95 offset:2432
    ds_write_addtid_b32 v96 offset:2720
    ds_write_addtid_b32 v97 offset:2976
    ds_write_addtid_b32 v98 offset:3264
    ds_write_addtid_b32 v99 offset:3520
    ds_write_addtid_b32 v100 offset:3808
    ds_write_addtid_b32 v101 offset:4064
    ds_write_addtid_b32 v102 offset:17408
    ds_write_addtid_b32 v103 offset:17664
    ds_write_addtid_b32 v104 offset:17952
    ds_write_addtid_b32 v105 offset:18208
    ds_write_addtid_b32 v106 offset:18496
    ds_write_addtid_b32 v107 offset:18752
    ds_write_addtid_b32 v108 offset:19040
    ds_write_addtid_b32 v109 offset:19296
    ds_write_addtid_b32 v110 offset:19584
    ds_write_addtid_b32 v111 offset:19840
    ds_write_addtid_b32 v112 offset:20128
    ds_write_addtid_b32 v113 offset:20384
    ds_write_addtid_b32 v114 offset:20672
    ds_write_addtid_b32 v115 offset:20928
    ds_write_addtid_b32 v116 offset:21216
    ds_write_addtid_b32 v117 offset:21472
    ds_read_b128 v[192:195], v42 offset:0
    ds_read_b128 v[196:199], v42 offset:64
    ds_read_b128 v[200:203], v42 offset:128
    ds_read_b128 v[204:207], v42 offset:192
    ds_read_b128 v[208:211], v42 offset:256
    ds_read_b128 v[212:215], v42 offset:320
    ds_read_b128 v[216:219], v42 offset:384
    ds_read_b128 v[220:223], v42 offset:448
    ds_write_addtid_b32 v224 offset:0
    ds_write_addtid_b32 v225 offset:256
    ds_write_addtid_b32 v226 offset:544
    ds_write_addtid_b32 v227 offset:800
    ds_write_addtid_b32 v228 offset:1088
    ds_write_addtid_b32 v229 offset:1344
    ds_write_addtid_b32 v230 offset:1632
    ds_write_addtid_b32 v231 offset:1888
    s_mov_b32 s99, 0
    s_load_dword s99, s[48:49], s76
    s_waitcnt lgkmcnt(14)
    v_mfma_f32_16x16x32_bf16 v[48:51], v[160:163], v[192:195], 0
    ds_write_addtid_b32 v232 offset:2176
    ds_write_addtid_b32 v233 offset:2432
    v_mfma_f32_16x16x32_bf16 v[48:51], v[164:167], v[196:199], v[48:51]
    ds_write_addtid_b32 v234 offset:2720
    ds_write_addtid_b32 v235 offset:2976
    s_waitcnt lgkmcnt(14)
    v_mfma_f32_16x16x32_bf16 v[48:51], v[168:171], v[200:203], v[48:51]
    ds_write_addtid_b32 v236 offset:3264
    ds_write_addtid_b32 v237 offset:3520
    v_mfma_f32_16x16x32_bf16 v[48:51], v[172:175], v[204:207], v[48:51]
    ds_write_addtid_b32 v238 offset:3808
    ds_write_addtid_b32 v239 offset:4064
    v_mfma_f32_16x16x32_bf16 v[48:51], v[176:179], v[208:211], v[48:51]
    ds_write_addtid_b32 v240 offset:17408
    ds_write_addtid_b32 v241 offset:17664
    v_mfma_f32_16x16x32_bf16 v[48:51], v[180:183], v[212:215], v[48:51]
    s_waitcnt lgkmcnt(14)
    ds_write_addtid_b32 v242 offset:17952
    ds_write_addtid_b32 v243 offset:18208
    v_mfma_f32_16x16x32_bf16 v[48:51], v[184:187], v[216:219], v[48:51]
    ds_write_addtid_b32 v244 offset:18496
    ds_write_addtid_b32 v245 offset:18752
    v_mfma_f32_16x16x32_bf16 v[48:51], v[188:191], v[220:223], v[48:51]
    ds_write_addtid_b32 v246 offset:19040
    ds_write_addtid_b32 v247 offset:19296
    v_mfma_f32_16x16x32_bf16 v[56:59], v[128:131], v[192:195], 0
    ds_write_addtid_b32 v248 offset:19584
    ds_write_addtid_b32 v249 offset:19840
    v_mfma_f32_16x16x32_bf16 v[56:59], v[132:135], v[196:199], v[56:59]
    ds_write_addtid_b32 v250 offset:20128
    ds_write_addtid_b32 v251 offset:20384
    v_mfma_f32_16x16x32_bf16 v[56:59], v[136:139], v[200:203], v[56:59]
    ds_write_addtid_b32 v252 offset:20672
    ds_write_addtid_b32 v253 offset:20928
    v_mfma_f32_16x16x32_bf16 v[56:59], v[140:143], v[204:207], v[56:59]
    ds_write_addtid_b32 v254 offset:21216
    ds_write_addtid_b32 v255 offset:21472
    v_mfma_f32_16x16x32_bf16 v[56:59], v[144:147], v[208:211], v[56:59]
    ds_read_b128 v[224:227], v42 offset:0
    ds_read_b128 v[228:231], v42 offset:64
    v_mfma_f32_16x16x32_bf16 v[56:59], v[148:151], v[212:215], v[56:59]
    ds_read_b128 v[232:235], v42 offset:128
    ds_read_b128 v[236:239], v42 offset:192
    v_mfma_f32_16x16x32_bf16 v[56:59], v[152:155], v[216:219], v[56:59]
    ds_read_b128 v[240:243], v42 offset:256
    ds_read_b128 v[244:247], v42 offset:320
    v_mfma_f32_16x16x32_bf16 v[56:59], v[156:159], v[220:223], v[56:59]
    s_cmp_lt_u32 s99, 7
    s_cbranch_scc1 L_slow1
L_back1:
    buffer_load_dwordx4 a[112:115], v34, s[64:67], s73 offen offset:0 sc1
    ds_read_b128 v[248:251], v42 offset:384
    ds_read_b128 v[252:255], v42 offset:448
    ds_write_b64 v43, v[48:49]
    ds_write_b64 v44, v[50:51]
    s_waitcnt lgkmcnt(9)
    v_mfma_f32_16x16x32_bf16 v[52:55], v[160:163], v[224:227], 0
    buffer_load_dwordx4 a[116:119], v34, s[64:67], s73 offen offset:1024 sc1
    s_waitcnt lgkmcnt(8)
    v_mfma_f32_16x16x32_bf16 v[52:55], v[164:167], v[228:231], v[52:55]
    s_waitcnt lgkmcnt(7)
    v_mfma_f32_16x16x32_bf16 v[52:55], v[168:171], v[232:235], v[52:55]
    s_waitcnt lgkmcnt(6)
    v_mfma_f32_16x16x32_bf16 v[52:55], v[172:175], v[236:239], v[52:55]
    ds_write2_b32 v82, v56, v57 offset0:0 offset1:32
    s_waitcnt lgkmcnt(6)
    v_mfma_f32_16x16x32_bf16 v[52:55], v[176:179], v[240:243], v[52:55]
    s_waitcnt lgkmcnt(5)
    v_mfma_f32_16x16x32_bf16 v[52:55], v[180:183], v[244:247], v[52:55]
    s_waitcnt lgkmcnt(4)
    buffer_load_dwordx4 a[120:123], v35, s[64:67], s73 offen offset:0 sc1
    v_mfma_f32_16x16x32_bf16 v[52:55], v[184:187], v[248:251], v[52:55]
    s_waitcnt lgkmcnt(3)
    ds_write2_b32 v82, v58, v59 offset0:64 offset1:96
    v_mfma_f32_16x16x32_bf16 v[52:55], v[188:191], v[252:255], v[52:55]
    v_mfma_f32_16x16x32_bf16 v[60:63], v[128:131], v[224:227], 0
    v_mfma_f32_16x16x32_bf16 v[60:63], v[132:135], v[228:231], v[60:63]
    buffer_load_dwordx4 a[124:127], v35, s[64:67], s73 offen offset:1024 sc1
    v_mfma_f32_16x16x32_bf16 v[60:63], v[136:139], v[232:235], v[60:63]
    s_add_u32 s73, s73, 4096
    s_nop 2
    ds_write_b64 v45, v[52:53]
    v_mfma_f32_16x16x32_bf16 v[60:63], v[140:143], v[236:239], v[60:63]
    ds_write_b64 v46, v[54:55]
    v_mfma_f32_16x16x32_bf16 v[60:63], v[144:147], v[240:243], v[60:63]
    v_mfma_f32_16x16x32_bf16 v[60:63], v[148:151], v[244:247], v[60:63]
    s_waitcnt vmcnt(22)
    ds_read_b32 v3, v1
    s_waitcnt lgkmcnt(1)
    s_barrier
    ds_read2st64_b32 v[92:93], v20 offset0:0 offset1:34
    ds_read2st64_b32 v[94:95], v20 offset0:17 offset1:51
    v_mfma_f32_16x16x32_bf16 v[60:63], v[152:155], v[248:251], v[60:63]
    s_waitcnt vmcnt(4)
    s_atomic_add s51, s[48:49], s74
    ds_read2st64_b32 v[96:97], v8 offset0:0 offset1:34
    ds_read2st64_b32 v[98:99], v8 offset0:17 offset1:51
    v_mfma_f32_16x16x32_bf16 v[60:63], v[156:159], v[252:255], v[60:63]
    s_add_u32 s76, s76, 32768
    ds_write_b32 v85, v83 offset:17408
    ds_write_b32 v85, v83 offset:21632
    ds_read_b64_tr_b16 v[192:193], v37 offset:32
    ds_read_b64_tr_b16 v[194:195], v37 offset:0
    ds_read_b64_tr_b16 v[196:197], v37 offset:288
    ds_read_b64_tr_b16 v[198:199], v37 offset:256
    ds_read_b64_tr_b16 v[200:201], v37 offset:544
    buffer_load_dwordx4 a[128:131], v34, s[64:67], s73 offen offset:0 sc1
    buffer_load_dwordx4 a[132:135], v34, s[64:67], s73 offen offset:1024 sc1
    ds_read_b64_tr_b16 v[202:203], v37 offset:512
    ds_read_b64_tr_b16 v[204:205], v37 offset:800
    ds_read_b64_tr_b16 v[206:207], v37 offset:768
    ds_write2_b32 v82, v60, v61 offset0:16 offset1:48
    ds_write2_b32 v82, v62, v63 offset0:80 offset1:112
    s_nop 0
    buffer_load_dwordx4 a[136:139], v35, s[64:67], s73 offen offset:0 sc1
    buffer_load_dwordx4 a[140:143], v35, s[64:67], s73 offen offset:1024 sc1
    s_waitcnt lgkmcnt(14)
    v_pk_add_f32 v[94:95], v[94:95], v[12:13]
    s_waitcnt lgkmcnt(12)
    v_pk_add_f32 v[96:97], v[96:97], v[98:99]
    s_add_u32 s73, s73, 4096
    v_pk_add_f32 v[92:93], v[92:93], v[94:95]
    v_cvt_pk_bf16_f32 v94, v92, v96
    v_cvt_pk_bf16_f32 v95, v93, v97
    ds_write_b32 v84, v94 offset:17504
    ds_write_b32 v84, v95 offset:21728
    ds_read_b64_tr_b16 v[208:209], v37 offset:1056
    ds_read_b64_tr_b16 v[210:211], v37 offset:1024
    ds_read_b64_tr_b16 v[212:213], v37 offset:1312
    ds_read_b64_tr_b16 v[214:215], v37 offset:1280
    ds_read_b64_tr_b16 v[216:217], v37 offset:1568
    ds_read_b64_tr_b16 v[218:219], v37 offset:1536
    ds_read_b64_tr_b16 v[220:221], v37 offset:1824
    ds_read_b64_tr_b16 v[222:223], v37 offset:1792
    s_waitcnt lgkmcnt(8)
    s_barrier
    ds_read_b64_tr_b16 v[48:49], v36 offset:0
    ds_read_b64_tr_b16 v[50:51], v36 offset:32
    ds_read_b64_tr_b16 v[52:53], v36 offset:256
    ds_read_b64_tr_b16 v[54:55], v36 offset:288
    ds_read_b64_tr_b16 v[56:57], v36 offset:512
    ds_read_b64_tr_b16 v[58:59], v36 offset:544
    s_waitcnt lgkmcnt(4)
    v_mfma_f32_16x16x32_bf16 v[128:131], v[48:51], v[192:195], 0
    ds_read_b64_tr_b16 v[224:225], v37 offset:2080
    ds_read_b64_tr_b16 v[226:227], v37 offset:2048
    v_mfma_f32_16x16x32_bf16 v[132:135], v[48:51], v[196:199], 0
    ds_read_b64_tr_b16 v[228:229], v37 offset:2336
    ds_read_b64_tr_b16 v[230:231], v37 offset:2304
    v_mfma_f32_16x16x32_bf16 v[136:139], v[48:51], v[200:203], 0
    ds_read_b64_tr_b16 v[232:233], v37 offset:2592
    ds_read_b64_tr_b16 v[234:235], v37 offset:2560
    v_mfma_f32_16x16x32_bf16 v[140:143], v[48:51], v[204:207], 0
    ds_read_b64_tr_b16 v[236:237], v37 offset:2848
    ds_read_b64_tr_b16 v[238:239], v37 offset:2816
    v_mfma_f32_16x16x32_bf16 v[144:147], v[48:51], v[208:211], 0
    ds_read_b64_tr_b16 v[240:241], v37 offset:3104
    ds_read_b64_tr_b16 v[242:243], v37 offset:3072
    v_mfma_f32_16x16x32_bf16 v[148:151], v[48:51], v[212:215], 0
    buffer_load_dwordx4 a[144:147], v34, s[64:67], s73 offen offset:0 sc1
    v_mfma_f32_16x16x32_bf16 v[152:155], v[48:51], v[216:219], 0
    ds_read_b64_tr_b16 v[244:245], v37 offset:3360
    ds_read_b64_tr_b16 v[246:247], v37 offset:3328
    v_mfma_f32_16x16x32_bf16 v[156:159], v[48:51], v[220:223], 0
    s_waitcnt lgkmcnt(10)
    ds_read_b64_tr_b16 v[248:249], v37 offset:3616
    ds_read_b64_tr_b16 v[250:251], v37 offset:3584
    v_mfma_f32_16x16x32_bf16 v[160:163], v[48:51], v[224:227], 0
    s_waitcnt lgkmcnt(10)
    ds_read_b64_tr_b16 v[252:253], v37 offset:3872
    ds_read_b64_tr_b16 v[254:255], v37 offset:3840
    v_mfma_f32_16x16x32_bf16 v[164:167], v[48:51], v[228:231], 0
    s_waitcnt lgkmcnt(10)
    buffer_load_dwordx4 a[148:151], v34, s[64:67], s73 offen offset:1024 sc1
    v_mfma_f32_16x16x32_bf16 v[168:171], v[48:51], v[232:235], 0
    s_waitcnt lgkmcnt(8)
    ds_read_b64_tr_b16 v[60:61], v36 offset:768
    ds_read2st64_b32 v[100:101], v21 offset0:0 offset1:34
    v_mfma_f32_16x16x32_bf16 v[172:175], v[48:51], v[236:239], 0
    s_waitcnt lgkmcnt(8)
    ds_read2st64_b32 v[102:103], v21 offset0:17 offset1:51
    ds_read2st64_b32 v[104:105], v9 offset0:0 offset1:34
    v_mfma_f32_16x16x32_bf16 v[176:179], v[48:51], v[240:243], 0
    s_waitcnt lgkmcnt(8)
    ds_read2st64_b32 v[106:107], v9 offset0:17 offset1:51
    ds_read_b64_tr_b16 v[62:63], v36 offset:800
    v_mfma_f32_16x16x32_bf16 v[180:183], v[48:51], v[244:247], 0
    s_waitcnt lgkmcnt(8)
    ds_read2st64_b32 v[108:109], v22 offset0:0 offset1:34
    ds_read2st64_b32 v[110:111], v22 offset0:17 offset1:51
    v_mfma_f32_16x16x32_bf16 v[184:187], v[48:51], v[248:251], 0
    s_waitcnt lgkmcnt(8)
    ds_read2st64_b32 v[112:113], v10 offset0:0 offset1:34
    buffer_load_dwordx4 a[152:155], v35, s[64:67], s73 offen offset:0 sc1
    v_mfma_f32_16x16x32_bf16 v[188:191], v[48:51], v[252:255], 0
    ds_read2st64_b32 v[114:115], v10 offset0:17 offset1:51
    ds_read2st64_b32 v[116:117], v23 offset0:0 offset1:34
    v_mfma_f32_16x16x32_bf16 v[132:135], v[52:55], v[192:195], v[132:135]
    ds_read2st64_b32 v[118:119], v23 offset0:17 offset1:51
    ds_read2st64_b32 v[120:121], v11 offset0:0 offset1:34
    v_mfma_f32_16x16x32_bf16 v[136:139], v[52:55], v[196:199], v[136:139]
    ds_read2st64_b32 v[122:123], v11 offset0:17 offset1:51
    buffer_load_dwordx4 a[156:159], v35, s[64:67], s73 offen offset:1024 sc1
    v_mfma_f32_16x16x32_bf16 v[140:143], v[52:55], v[200:203], v[140:143]
    s_add_u32 s73, s73, 4096
    v_add_f32_dpp v130, v131, v130 wave_shr:1 row_mask:0xf bank_mask:0xf
    s_waitcnt lgkmcnt(11)
    v_add_f32 v100, v100, v102
    v_mfma_f32_16x16x32_bf16 v[144:147], v[52:55], v[204:207], v[144:147]
    s_waitcnt lgkmcnt(9)
    v_add_f32 v104, v104, v106
    v_add_f32 v101, v101, v103
    v_mfma_f32_16x16x32_bf16 v[148:151], v[52:55], v[208:211], v[148:151]
    v_add_f32_e64 v105, v105, v107
    v_add_f32_dpp v129, v130, v129 wave_shr:1 row_mask:0xf bank_mask:0xf
    v_mfma_f32_16x16x32_bf16 v[152:155], v[52:55], v[212:215], v[152:155]
    v_cvt_pk_bf16_f32 v102, v100, v104
    v_cvt_pk_bf16_f32 v103, v101, v105
    v_mfma_f32_16x16x32_bf16 v[156:159], v[52:55], v[216:219], v[156:159]
    buffer_load_dwordx4 a[160:163], v34, s[64:67], s73 offen offset:0 sc1
    v_mfma_f32_16x16x32_bf16 v[160:163], v[52:55], v[220:223], v[160:163]
    s_waitcnt lgkmcnt(6)
    v_add_f32 v108, v108, v110
    s_waitcnt lgkmcnt(4)
    v_add_f32 v112, v112, v114
    v_mfma_f32_16x16x32_bf16 v[164:167], v[52:55], v[224:227], v[164:167]
    v_add_f32 v109, v109, v111
    v_add_f32 v113, v113, v115
    v_mfma_f32_16x16x32_bf16 v[168:171], v[52:55], v[228:231], v[168:171]
    v_cvt_pk_bf16_f32 v110, v108, v112
    v_add_f32_dpp v128, v129, v128 wave_shr:1 row_mask:0xf bank_mask:0xf
    v_mfma_f32_16x16x32_bf16 v[172:175], v[52:55], v[232:235], v[172:175]
    buffer_load_dwordx4 a[164:167], v34, s[64:67], s73 offen offset:1024 sc1
    v_mfma_f32_16x16x32_bf16 v[176:179], v[52:55], v[236:239], v[176:179]
    v_cvt_pk_bf16_f32 v111, v109, v113
    s_waitcnt lgkmcnt(2)
    v_add_f32 v116, v116, v118
    v_mfma_f32_16x16x32_bf16 v[180:183], v[52:55], v[240:243], v[180:183]
    ds_read_b32 v3, v1
    s_waitcnt lgkmcnt(1)
    v_add_f32 v120, v120, v122
    v_add_f32 v117, v117, v119
    v_mfma_f32_16x16x32_bf16 v[184:187], v[52:55], v[244:247], v[184:187]
    v_add_f32 v121, v121, v123
    v_cvt_pk_bf16_f32 v118, v116, v120
    v_mfma_f32_16x16x32_bf16 v[188:191], v[52:55], v[248:251], v[188:191]
    ds_write_b32 v84, v102 offset:18528
    v_mfma_f32_16x16x32_bf16 v[136:139], v[56:59], v[192:195], v[136:139]
    buffer_load_dwordx4 a[168:171], v35, s[64:67], s73 offen offset:0 sc1
    v_mfma_f32_16x16x32_bf16 v[140:143], v[56:59], v[196:199], v[140:143]
    ds_write_b32 v84, v103 offset:22752
    v_mfma_f32_16x16x32_bf16 v[144:147], v[56:59], v[200:203], v[144:147]
    v_cvt_pk_bf16_f32 v119, v117, v121
    v_add_f32_dpp v134, v135, v134 wave_shr:1 row_mask:0xf bank_mask:0xf
    v_mfma_f32_16x16x32_bf16 v[148:151], v[56:59], v[204:207], v[148:151]
    ds_write_b32 v84, v110 offset:19552
    v_mfma_f32_16x16x32_bf16 v[152:155], v[56:59], v[208:211], v[152:155]
    ds_write_b32 v84, v111 offset:23776
    v_mfma_f32_16x16x32_bf16 v[156:159], v[56:59], v[212:215], v[156:159]
    buffer_load_dwordx4 a[172:175], v35, s[64:67], s73 offen offset:1024 sc1
    v_mfma_f32_16x16x32_bf16 v[160:163], v[56:59], v[216:219], v[160:163]
    s_add_u32 s73, s73, 4096
    ds_write_b32 v84, v118 offset:20576
    v_mfma_f32_16x16x32_bf16 v[164:167], v[56:59], v[220:223], v[164:167]
    ds_write_b32 v84, v119 offset:24800
    v_mfma_f32_16x16x32_bf16 v[168:171], v[56:59], v[224:227], v[168:171]
    v_add_f32_dpp v133, v134, v133 wave_shr:1 row_mask:0xf bank_mask:0xf
    v_mov_b32_dpp v135, v131 wave_shl:1 row_mask:0xf bank_mask:0xf
    v_mfma_f32_16x16x32_bf16 v[172:175], v[56:59], v[228:231], v[172:175]
    buffer_load_dwordx4 a[176:179], v34, s[64:67], s73 offen offset:0 sc1
    v_mfma_f32_16x16x32_bf16 v[176:179], v[56:59], v[232:235], v[176:179]
    v_add_f32_dpp v132, v133, v132 wave_shr:1 row_mask:0xf bank_mask:0xf
    v_mov_b32_dpp v134, v130 wave_shl:1 row_mask:0xf bank_mask:0xf
    v_mfma_f32_16x16x32_bf16 v[180:183], v[56:59], v[236:239], v[180:183]
    v_mov_b32_dpp v133, v129 wave_shl:1 row_mask:0xf bank_mask:0xf
    v_mfma_f32_16x16x32_bf16 v[184:187], v[56:59], v[240:243], v[184:187]
    v_add_f32_dpp v138, v139, v138 wave_shr:1 row_mask:0xf bank_mask:0xf
    v_mfma_f32_16x16x32_bf16 v[188:191], v[56:59], v[244:247], v[188:191]
    s_nop 0
    v_add_f32_dpp v137, v138, v137 wave_shr:1 row_mask:0xf bank_mask:0xf
    v_mfma_f32_16x16x32_bf16 v[140:143], v[60:63], v[192:195], v[140:143]
    buffer_load_dwordx4 a[180:183], v34, s[64:67], s73 offen offset:1024 sc1
    v_mfma_f32_16x16x32_bf16 v[144:147], v[60:63], v[196:199], v[144:147]
    ds_read_b32 v3, v1
    s_waitcnt lgkmcnt(1)
    s_barrier
    ds_read_b64_tr_b16 v[48:49], v36 offset:1024
    v_mfma_f32_16x16x32_bf16 v[148:151], v[60:63], v[200:203], v[148:151]
    ds_read_b64_tr_b16 v[50:51], v36 offset:1056
    v_mfma_f32_16x16x32_bf16 v[152:155], v[60:63], v[204:207], v[152:155]
    ds_read_b64_tr_b16 v[52:53], v36 offset:1280
    v_mfma_f32_16x16x32_bf16 v[156:159], v[60:63], v[208:211], v[156:159]
    buffer_load_dwordx4 a[184:187], v35, s[64:67], s73 offen offset:0 sc1
    v_mfma_f32_16x16x32_bf16 v[160:163], v[60:63], v[212:215], v[160:163]
    ds_read_b64_tr_b16 v[54:55], v36 offset:1312
    v_mfma_f32_16x16x32_bf16 v[164:167], v[60:63], v[216:219], v[164:167]
    ds_read_b64_tr_b16 v[56:57], v36 offset:1536
    v_add_f32_dpp v136, v137, v136 wave_shr:1 row_mask:0xf bank_mask:0xf
    v_mfma_f32_16x16x32_bf16 v[168:171], v[60:63], v[220:223], v[168:171]
    ds_read_b64_tr_b16 v[58:59], v36 offset:1568
    v_mfma_f32_16x16x32_bf16 v[172:175], v[60:63], v[224:227], v[172:175]
    v_mov_b32_dpp v139, v135 wave_shl:1 row_mask:0xf bank_mask:0xf
    v_mfma_f32_16x16x32_bf16 v[176:179], v[60:63], v[228:231], v[176:179]
    buffer_load_dwordx4 a[188:191], v35, s[64:67], s73 offen offset:1024 sc1
    v_mfma_f32_16x16x32_bf16 v[180:183], v[60:63], v[232:235], v[180:183]
    s_add_u32 s73, s73, 4096
    v_mov_b32_dpp v138, v134 wave_shl:1 row_mask:0xf bank_mask:0xf
    v_mfma_f32_16x16x32_bf16 v[184:187], v[60:63], v[236:239], v[184:187]
    s_mov_b32 s99, 0
    v_mov_b32_dpp v137, v133 wave_shl:1 row_mask:0xf bank_mask:0xf
    v_mfma_f32_16x16x32_bf16 v[188:191], v[60:63], v[240:243], v[188:191]
    s_waitcnt lgkmcnt(4)
    s_load_dword s99, s[48:49], s76
    v_add_f32_dpp v142, v143, v142 wave_shr:1 row_mask:0xf bank_mask:0xf
    v_mfma_f32_16x16x32_bf16 v[144:147], v[48:51], v[192:195], v[144:147]
    buffer_load_dwordx4 a[192:195], v34, s[64:67], s73 offen offset:0 sc1
    v_mfma_f32_16x16x32_bf16 v[148:151], v[48:51], v[196:199], v[148:151]
    ds_read_b64_tr_b16 v[60:61], v36 offset:1792
    v_mfma_f32_16x16x32_bf16 v[152:155], v[48:51], v[200:203], v[152:155]
    ds_read_b64_tr_b16 v[62:63], v36 offset:1824
    v_mfma_f32_16x16x32_bf16 v[156:159], v[48:51], v[204:207], v[156:159]
    v_add_f32_dpp v141, v142, v141 wave_shr:1 row_mask:0xf bank_mask:0xf
    v_mfma_f32_16x16x32_bf16 v[160:163], v[48:51], v[208:211], v[160:163]
    s_nop 0
    v_add_f32_dpp v140, v141, v140 wave_shr:1 row_mask:0xf bank_mask:0xf
    v_mfma_f32_16x16x32_bf16 v[164:167], v[48:51], v[212:215], v[164:167]
    buffer_load_dwordx4 a[196:199], v34, s[64:67], s73 offen offset:1024 sc1
    v_mfma_f32_16x16x32_bf16 v[168:171], v[48:51], v[216:219], v[168:171]
    v_mov_b32_dpp v143, v139 wave_shl:1 row_mask:0xf bank_mask:0xf
    v_mfma_f32_16x16x32_bf16 v[172:175], v[48:51], v[220:223], v[172:175]
    v_mov_b32_dpp v142, v138 wave_shl:1 row_mask:0xf bank_mask:0xf
    v_mfma_f32_16x16x32_bf16 v[176:179], v[48:51], v[224:227], v[176:179]
    v_mov_b32_dpp v141, v137 wave_shl:1 row_mask:0xf bank_mask:0xf
    v_mfma_f32_16x16x32_bf16 v[180:183], v[48:51], v[228:231], v[180:183]
    v_add_f32_dpp v146, v147, v146 wave_shr:1 row_mask:0xf bank_mask:0xf
    v_mfma_f32_16x16x32_bf16 v[184:187], v[48:51], v[232:235], v[184:187]
    buffer_load_dwordx4 a[200:203], v35, s[64:67], s73 offen offset:0 sc1
    v_mfma_f32_16x16x32_bf16 v[188:191], v[48:51], v[236:239], v[188:191]
    s_waitcnt lgkmcnt(4)
    v_add_f32_dpp v145, v146, v145 wave_shr:1 row_mask:0xf bank_mask:0xf
    v_mfma_f32_16x16x32_bf16 v[148:151], v[52:55], v[192:195], v[148:151]
    ds_read_b64_tr_b16 v[48:49], v36 offset:2048
    v_mfma_f32_16x16x32_bf16 v[152:155], v[52:55], v[196:199], v[152:155]
    ds_read_b64_tr_b16 v[50:51], v36 offset:2080
    v_mfma_f32_16x16x32_bf16 v[156:159], v[52:55], v[200:203], v[156:159]
    buffer_load_dwordx4 a[204:207], v35, s[64:67], s73 offen offset:1024 sc1
    v_mfma_f32_16x16x32_bf16 v[160:163], v[52:55], v[204:207], v[160:163]
    s_add_u32 s73, s73, 4096
    v_add_f32_dpp v144, v145, v144 wave_shr:1 row_mask:0xf bank_mask:0xf
    v_mfma_f32_16x16x32_bf16 v[164:167], v[52:55], v[208:211], v[164:167]
L_st5:
    s_cbranch_execz L_hopret
    v_mov_b32_dpp v147, v143 wave_shl:1 row_mask:0xf bank_mask:0xf
    v_mfma_f32_16x16x32_bf16 v[168:171], v[52:55], v[212:215], v[168:171]
    v_mov_b32_dpp v146, v142 wave_shl:1 row_mask:0xf bank_mask:0xf
    v_mfma_f32_16x16x32_bf16 v[172:175], v[52:55], v[216:219], v[172:175]
    v_mov_b32_dpp v145, v141 wave_shl:1 row_mask:0xf bank_mask:0xf
    v_mfma_f32_16x16x32_bf16 v[176:179], v[52:55], v[220:223], v[176:179]
    buffer_load_dwordx4 a[208:211], v34, s[64:67], s73 offen offset:0 sc1
    v_mfma_f32_16x16x32_bf16 v[180:183], v[52:55], v[224:227], v[180:183]
    v_add_f32_dpp v150, v151, v150 wave_shr:1 row_mask:0xf bank_mask:0xf
    v_mfma_f32_16x16x32_bf16 v[184:187], v[52:55], v[228:231], v[184:187]
    s_nop 0
    v_add_f32_dpp v149, v150, v149 wave_shr:1 row_mask:0xf bank_mask:0xf
    v_mfma_f32_16x16x32_bf16 v[188:191], v[52:55], v[232:235], v[188:191]
    s_waitcnt lgkmcnt(4)
    v_add_f32_dpp v148, v149, v148 wave_shr:1 row_mask:0xf bank_mask:0xf
    v_mfma_f32_16x16x32_bf16 v[152:155], v[56:59], v[192:195], v[152:155]
    buffer_load_dwordx4 a[212:215], v34, s[64:67], s73 offen offset:1024 sc1
    v_mfma_f32_16x16x32_bf16 v[156:159], v[56:59], v[196:199], v[156:159]
    ds_read_b64_tr_b16 v[52:53], v36 offset:2304
    ds_read_b64_tr_b16 v[54:55], v36 offset:2336
    v_mfma_f32_16x16x32_bf16 v[160:163], v[56:59], v[200:203], v[160:163]
    v_mov_b32_dpp v151, v147 wave_shl:1 row_mask:0xf bank_mask:0xf
    v_mfma_f32_16x16x32_bf16 v[164:167], v[56:59], v[204:207], v[164:167]
    v_mov_b32_dpp v150, v146 wave_shl:1 row_mask:0xf bank_mask:0xf
    v_mfma_f32_16x16x32_bf16 v[168:171], v[56:59], v[208:211], v[168:171]
    v_mov_b32_dpp v149, v145 wave_shl:1 row_mask:0xf bank_mask:0xf
    v_mfma_f32_16x16x32_bf16 v[172:175], v[56:59], v[212:215], v[172:175]
    buffer_load_dwordx4 a[216:219], v35, s[64:67], s73 offen offset:0 sc1
    v_mfma_f32_16x16x32_bf16 v[176:179], v[56:59], v[216:219], v[176:179]
    v_add_f32_dpp v154, v155, v154 wave_shr:1 row_mask:0xf bank_mask:0xf
    v_mfma_f32_16x16x32_bf16 v[180:183], v[56:59], v[220:223], v[180:183]
    s_nop 0
    v_add_f32_dpp v153, v154, v153 wave_shr:1 row_mask:0xf bank_mask:0xf
    v_mfma_f32_16x16x32_bf16 v[184:187], v[56:59], v[224:227], v[184:187]
    v_mfma_f32_16x16x32_bf16 v[188:191], v[56:59], v[228:231], v[188:191]
    s_waitcnt lgkmcnt(4)
    buffer_load_dwordx4 a[220:223], v35, s[64:67], s73 offen offset:1024 sc1
    v_mfma_f32_16x16x32_bf16 v[156:159], v[60:63], v[192:195], v[156:159]
    s_add_u32 s73, s73, 90112
    ds_read_b64_tr_b16 v[56:57], v36 offset:2560
    v_mfma_f32_16x16x32_bf16 v[160:163], v[60:63], v[196:199], v[160:163]
    ds_read_b64_tr_b16 v[58:59], v36 offset:2592
    v_mfma_f32_16x16x32_bf16 v[164:167], v[60:63], v[200:203], v[164:167]
    v_mfma_f32_16x16x32_bf16 v[168:171], v[60:63], v[204:207], v[168:171]
    v_mfma_f32_16x16x32_bf16 v[172:175], v[60:63], v[208:211], v[172:175]
    s_cmp_lt_u32 s99, 7
    s_cbranch_scc1 L_slow2
L_back2:
    buffer_load_dwordx4 a[224:227], v34, s[64:67], s73 offen offset:0 sc1
    v_mfma_f32_16x16x32_bf16 v[176:179], v[60:63], v[212:215], v[176:179]
    v_add_f32_dpp v152, v153, v152 wave_shr:1 row_mask:0xf bank_mask:0xf
    v_mfma_f32_16x16x32_bf16 v[180:183], v[60:63], v[216:219], v[180:183]
    v_mov_b32_dpp v155, v151 wave_shl:1 row_mask:0xf bank_mask:0xf
    v_mfma_f32_16x16x32_bf16 v[184:187], v[60:63], v[220:223], v[184:187]
    v_mov_b32_dpp v154, v150 wave_shl:1 row_mask:0xf bank_mask:0xf
    v_mfma_f32_16x16x32_bf16 v[188:191], v[60:63], v[224:227], v[188:191]
    s_waitcnt lgkmcnt(4)
    v_mov_b32_dpp v153, v149 wave_shl:1 row_mask:0xf bank_mask:0xf
    v_mfma_f32_16x16x32_bf16 v[160:163], v[48:51], v[192:195], v[160:163]
    buffer_load_dwordx4 a[228:231], v34, s[64:67], s73 offen offset:1024 sc1
    v_mfma_f32_16x16x32_bf16 v[164:167], v[48:51], v[196:199], v[164:167]
    ds_read_b64_tr_b16 v[60:61], v36 offset:2816
    ds_read_b64_tr_b16 v[62:63], v36 offset:2848
    v_mfma_f32_16x16x32_bf16 v[168:171], v[48:51], v[200:203], v[168:171]
    v_add_f32_dpp v158, v159, v158 wave_shr:1 row_mask:0xf bank_mask:0xf
    v_mfma_f32_16x16x32_bf16 v[172:175], v[48:51], v[204:207], v[172:175]
    s_nop 0
    v_add_f32_dpp v157, v158, v157 wave_shr:1 row_mask:0xf bank_mask:0xf
    v_mfma_f32_16x16x32_bf16 v[176:179], v[48:51], v[208:211], v[176:179]
    buffer_load_dwordx4 a[232:235], v35, s[64:67], s73 offen offset:0 sc1
    v_mfma_f32_16x16x32_bf16 v[180:183], v[48:51], v[212:215], v[180:183]
    v_add_f32_dpp v156, v157, v156 wave_shr:1 row_mask:0xf bank_mask:0xf
    v_mov_b32_dpp v159, v155 wave_shl:1 row_mask:0xf bank_mask:0xf
    v_mfma_f32_16x16x32_bf16 v[184:187], v[48:51], v[216:219], v[184:187]
    v_mov_b32_dpp v158, v154 wave_shl:1 row_mask:0xf bank_mask:0xf
    v_mfma_f32_16x16x32_bf16 v[188:191], v[48:51], v[220:223], v[188:191]
    s_waitcnt lgkmcnt(4)
    v_mov_b32_dpp v157, v153 wave_shl:1 row_mask:0xf bank_mask:0xf
    v_mfma_f32_16x16x32_bf16 v[164:167], v[52:55], v[192:195], v[164:167]
    ds_read_b64_tr_b16 v[48:49], v36 offset:3072
    ds_read_b64_tr_b16 v[50:51], v36 offset:3104
    v_mfma_f32_16x16x32_bf16 v[168:171], v[52:55], v[196:199], v[168:171]
    buffer_load_dwordx4 a[236:239], v35, s[64:67], s73 offen offset:1024 sc1
    v_mfma_f32_16x16x32_bf16 v[172:175], v[52:55], v[200:203], v[172:175]
    s_add_u32 s73, s73, 4096
    v_add_f32_dpp v162, v163, v162 wave_shr:1 row_mask:0xf bank_mask:0xf
    v_mfma_f32_16x16x32_bf16 v[176:179], v[52:55], v[204:207], v[176:179]
    s_nop 0
    v_add_f32_dpp v161, v162, v161 wave_shr:1 row_mask:0xf bank_mask:0xf
    v_mfma_f32_16x16x32_bf16 v[180:183], v[52:55], v[208:211], v[180:183]
    s_nop 0
    v_add_f32_dpp v160, v161, v160 wave_shr:1 row_mask:0xf bank_mask:0xf
    v_mov_b32_dpp v163, v159 wave_shl:1 row_mask:0xf bank_mask:0xf
    v_mfma_f32_16x16x32_bf16 v[184:187], v[52:55], v[212:215], v[184:187]
    buffer_load_dwordx4 a[240:243], v34, s[64:67], s73 offen offset:0 sc1
    v_mfma_f32_16x16x32_bf16 v[188:191], v[52:55], v[216:219], v[188:191]
    s_waitcnt lgkmcnt(4)
    v_mov_b32_dpp v162, v158 wave_shl:1 row_mask:0xf bank_mask:0xf
    v_mov_b32_dpp v161, v157 wave_shl:1 row_mask:0xf bank_mask:0xf
    v_mfma_f32_16x16x32_bf16 v[168:171], v[56:59], v[192:195], v[168:171]
    ds_read_b64_tr_b16 v[52:53], v36 offset:3328
    ds_read_b64_tr_b16 v[54:55], v36 offset:3360
    v_mfma_f32_16x16x32_bf16 v[172:175], v[56:59], v[196:199], v[172:175]
    v_add_f32_dpp v166, v167, v166 wave_shr:1 row_mask:0xf bank_mask:0xf
    v_mfma_f32_16x16x32_bf16 v[176:179], v[56:59], v[200:203], v[176:179]
    s_nop 0
    v_add_f32_dpp v165, v166, v165 wave_shr:1 row_mask:0xf bank_mask:0xf
    v_mfma_f32_16x16x32_bf16 v[180:183], v[56:59], v[204:207], v[180:183]
    buffer_load_dwordx4 a[244:247], v34, s[64:67], s73 offen offset:1024 sc1
    v_mfma_f32_16x16x32_bf16 v[184:187], v[56:59], v[208:211], v[184:187]
    v_add_f32_dpp v164, v165, v164 wave_shr:1 row_mask:0xf bank_mask:0xf
    v_mov_b32_dpp v167, v163 wave_shl:1 row_mask:0xf bank_mask:0xf
    v_mfma_f32_16x16x32_bf16 v[188:191], v[56:59], v[212:215], v[188:191]
    s_waitcnt lgkmcnt(4)
    v_mov_b32_dpp v166, v162 wave_shl:1 row_mask:0xf bank_mask:0xf
    v_mov_b32_dpp v165, v161 wave_shl:1 row_mask:0xf bank_mask:0xf
    v_mfma_f32_16x16x32_bf16 v[172:175], v[60:63], v[192:195], v[172:175]
    ds_read_b64_tr_b16 v[56:57], v36 offset:3584
    ds_read_b64_tr_b16 v[58:59], v36 offset:3616
    v_mfma_f32_16x16x32_bf16 v[176:179], v[60:63], v[196:199], v[176:179]
    buffer_load_dwordx4 a[248:251], v35, s[64:67], s73 offen offset:0 sc1
    v_mfma_f32_16x16x32_bf16 v[180:183], v[60:63], v[200:203], v[180:183]
    v_add_f32_dpp v170, v171, v170 wave_shr:1 row_mask:0xf bank_mask:0xf
    v_mfma_f32_16x16x32_bf16 v[184:187], v[60:63], v[204:207], v[184:187]
    s_nop 0
    v_add_f32_dpp v169, v170, v169 wave_shr:1 row_mask:0xf bank_mask:0xf
    v_mov_b32_dpp v171, v167 wave_shl:1 row_mask:0xf bank_mask:0xf
    v_mfma_f32_16x16x32_bf16 v[188:191], v[60:63], v[208:211], v[188:191]
    s_waitcnt lgkmcnt(4)
    v_add_f32_dpp v168, v169, v168 wave_shr:1 row_mask:0xf bank_mask:0xf
    v_mov_b32_dpp v170, v166 wave_shl:1 row_mask:0xf bank_mask:0xf
    v_mfma_f32_16x16x32_bf16 v[176:179], v[48:51], v[192:195], v[176:179]
    ds_read_b64_tr_b16 v[60:61], v36 offset:3840
    ds_read_b64_tr_b16 v[62:63], v36 offset:3872
    v_mfma_f32_16x16x32_bf16 v[180:183], v[48:51], v[196:199], v[180:183]
    buffer_load_dwordx4 a[252:255], v35, s[64:67], s73 offen offset:1024 sc1
    v_mfma_f32_16x16x32_bf16 v[184:187], v[48:51], v[200:203], v[184:187]
    s_add_u32 s73, s73, 4096
    v_mov_b32_dpp v169, v165 wave_shl:1 row_mask:0xf bank_mask:0xf
    v_add_f32_dpp v174, v175, v174 wave_shr:1 row_mask:0xf bank_mask:0xf
    v_mfma_f32_16x16x32_bf16 v[188:191], v[48:51], v[204:207], v[188:191]
    s_waitcnt lgkmcnt(4)
    v_add_f32_dpp v173, v174, v173 wave_shr:1 row_mask:0xf bank_mask:0xf
    v_mov_b32_dpp v175, v171 wave_shl:1 row_mask:0xf bank_mask:0xf
    v_mfma_f32_16x16x32_bf16 v[180:183], v[52:55], v[192:195], v[180:183]
    v_add_f32_dpp v172, v173, v172 wave_shr:1 row_mask:0xf bank_mask:0xf
    v_mov_b32_dpp v174, v170 wave_shl:1 row_mask:0xf bank_mask:0xf
    v_mfma_f32_16x16x32_bf16 v[184:187], v[52:55], v[196:199], v[184:187]
    v_mov_b32_dpp v173, v169 wave_shl:1 row_mask:0xf bank_mask:0xf
    v_add_f32_dpp v178, v179, v178 wave_shr:1 row_mask:0xf bank_mask:0xf
    v_mfma_f32_16x16x32_bf16 v[188:191], v[52:55], v[200:203], v[188:191]
    s_waitcnt lgkmcnt(2)
    v_add_f32_dpp v177, v178, v177 wave_shr:1 row_mask:0xf bank_mask:0xf
    v_mov_b32_dpp v179, v175 wave_shl:1 row_mask:0xf bank_mask:0xf
    v_mfma_f32_16x16x32_bf16 v[184:187], v[56:59], v[192:195], v[184:187]
    s_mov_b32 m0, s8
    v_add_f32_dpp v176, v177, v176 wave_shr:1 row_mask:0xf bank_mask:0xf
    v_mov_b32_dpp v178, v174 wave_shl:1 row_mask:0xf bank_mask:0xf
    v_mfma_f32_16x16x32_bf16 v[188:191], v[56:59], v[196:199], v[188:191]
    ds_read_b32 v3, v1
    s_waitcnt lgkmcnt(1)
    v_mov_b32_dpp v177, v173 wave_shl:1 row_mask:0xf bank_mask:0xf
    v_add_f32_dpp v182, v183, v182 wave_shr:1 row_mask:0xf bank_mask:0xf
    v_mfma_f32_16x16x32_bf16 v[188:191], v[60:63], v[192:195], v[188:191]
    s_waitcnt vmcnt(35)
    v_add_f32_dpp v181, v182, v181 wave_shr:1 row_mask:0xf bank_mask:0xf
    v_mov_b32_dpp v183, v179 wave_shl:1 row_mask:0xf bank_mask:0xf
    v_mfma_f32_16x16x32_bf16 v[64:67], a[0:3], a[112:115], 0
    v_add_f32_dpp v180, v181, v180 wave_shr:1 row_mask:0xf bank_mask:0xf
    v_mov_b32_dpp v182, v178 wave_shl:1 row_mask:0xf bank_mask:0xf
    v_mfma_f32_16x16x32_bf16 v[72:75], a[4:7], a[112:115], 0
    v_mov_b32_dpp v181, v177 wave_shl:1 row_mask:0xf bank_mask:0xf
    v_add_f32_dpp v186, v187, v186 wave_shr:1 row_mask:0xf bank_mask:0xf
    v_mfma_f32_16x16x32_bf16 v[80:83], a[8:11], a[112:115], 0
    buffer_load_dwordx4 v[240:243], v34, s[64:67], s73 offen offset:0 sc1
    v_mfma_f32_16x16x32_bf16 v[88:91], a[12:15], a[112:115], 0
    s_waitcnt vmcnt(35)
    v_add_f32_dpp v185, v186, v185 wave_shr:1 row_mask:0xf bank_mask:0xf
    v_mov_b32_dpp v187, v183 wave_shl:1 row_mask:0xf bank_mask:0xf
    v_mfma_f32_16x16x32_bf16 v[92:95], a[12:15], a[116:119], 0
    v_add_f32_dpp v184, v185, v184 wave_shr:1 row_mask:0xf bank_mask:0xf
    v_mov_b32_dpp v186, v182 wave_shl:1 row_mask:0xf bank_mask:0xf
    v_mfma_f32_16x16x32_bf16 v[84:87], a[8:11], a[116:119], 0
    ds_write_addtid_b32 v128 offset:0
    ds_write_addtid_b32 v132 offset:544
    v_mfma_f32_16x16x32_bf16 v[76:79], a[4:7], a[116:119], 0
    buffer_load_dwordx4 v[244:247], v34, s[64:67], s73 offen offset:1024 sc1
    v_mfma_f32_16x16x32_bf16 v[68:71], a[0:3], a[116:119], 0
    s_waitcnt vmcnt(35)
    ds_write_addtid_b32 v136 offset:1088
    ds_write_addtid_b32 v140 offset:1632
    v_mfma_f32_16x16x32_bf16 v[96:99], a[0:3], a[120:123], 0
    ds_write_addtid_b32 v144 offset:2176
    ds_write_addtid_b32 v148 offset:2720
    v_mfma_f32_16x16x32_bf16 v[104:107], a[4:7], a[120:123], 0
    ds_write_addtid_b32 v152 offset:3264
    ds_write_addtid_b32 v156 offset:3808
    v_mfma_f32_16x16x32_bf16 v[112:115], a[8:11], a[120:123], 0
    ds_write_addtid_b32 v160 offset:4352
    ds_write_addtid_b32 v164 offset:4896
    v_mfma_f32_16x16x32_bf16 v[120:123], a[12:15], a[120:123], 0
    s_waitcnt vmcnt(34)
    buffer_load_dwordx4 v[248:251], v35, s[64:67], s73 offen offset:0 sc1
    v_mfma_f32_16x16x32_bf16 v[124:127], a[12:15], a[124:127], 0
    ds_write_addtid_b32 v168 offset:5440
    ds_write_addtid_b32 v172 offset:5984
    v_mfma_f32_16x16x32_bf16 v[116:119], a[8:11], a[124:127], 0
    ds_write_addtid_b32 v176 offset:6528
    ds_write_addtid_b32 v180 offset:7072
    v_mfma_f32_16x16x32_bf16 v[108:111], a[4:7], a[124:127], 0
    ds_write_addtid_b32 v184 offset:7616
    v_mov_b32_dpp v185, v181 wave_shl:1 row_mask:0xf bank_mask:0xf
    v_mfma_f32_16x16x32_bf16 v[100:103], a[0:3], a[124:127], 0
    s_waitcnt vmcnt(34)
    v_add_f32_dpp v190, v191, v190 wave_shr:1 row_mask:0xf bank_mask:0xf
    v_mov_b32_dpp v191, v187 wave_shl:1 row_mask:0xf bank_mask:0xf
    v_mfma_f32_16x16x32_bf16 v[64:67], a[16:19], a[128:131], v[64:67]
    buffer_load_dwordx4 v[252:255], v35, s[64:67], s73 offen offset:1024 sc1
    v_mfma_f32_16x16x32_bf16 v[72:75], a[20:23], a[128:131], v[72:75]
    s_add_u32 s73, s73, 4096
    v_add_f32_dpp v189, v190, v189 wave_shr:1 row_mask:0xf bank_mask:0xf
    v_mov_b32_dpp v190, v186 wave_shl:1 row_mask:0xf bank_mask:0xf
    v_mfma_f32_16x16x32_bf16 v[80:83], a[24:27], a[128:131], v[80:83]
    v_add_f32_dpp v188, v189, v188 wave_shr:1 row_mask:0xf bank_mask:0xf
    v_mov_b32_dpp v189, v185 wave_shl:1 row_mask:0xf bank_mask:0xf
    v_mfma_f32_16x16x32_bf16 v[88:91], a[28:31], a[128:131], v[88:91]
    s_waitcnt vmcnt(34)
    ds_write_addtid_b32 v188 offset:8160
    ds_write_b128 v38, v[188:191]
    v_mfma_f32_16x16x32_bf16 v[92:95], a[28:31], a[132:135], v[92:95]
    s_add_u32 m0, s9, 0
    s_nop 0
    buffer_load_dwordx4 v16, s[60:63], s7 offen offset:0 lds
    v_mfma_f32_16x16x32_bf16 v[84:87], a[24:27], a[132:135], v[84:87]
    s_add_u32 s78, s78, 1835008
    v_mfma_f32_16x16x32_bf16 v[76:79], a[20:23], a[132:135], v[76:79]
    buffer_load_dwordx4 v17, s[60:63], s7 offen offset:1024 lds
    v_mfma_f32_16x16x32_bf16 v[68:71], a[16:19], a[132:135], v[68:71]
    s_waitcnt vmcnt(35) lgkmcnt(0)
    s_barrier
    ds_read_b128 v[128:131], v39 offset:0
    v_mfma_f32_16x16x32_bf16 v[96:99], a[16:19], a[136:139], v[96:99]
    ds_read_b128 v[136:139], v40
    v_mfma_f32_16x16x32_bf16 v[104:107], a[20:23], a[136:139], v[104:107]
    ds_read_b128 v[132:135], v39 offset:16
    v_mfma_f32_16x16x32_bf16 v[112:115], a[24:27], a[136:139], v[112:115]
    buffer_load_dwordx4 v18, s[60:63], s7 offen offset:2048 lds
    v_mfma_f32_16x16x32_bf16 v[120:123], a[28:31], a[136:139], v[120:123]
    s_waitcnt vmcnt(35)
    ds_read_b128 v[140:143], v39 offset:8704
    v_mfma_f32_16x16x32_bf16 v[124:127], a[28:31], a[140:143], v[124:127]
    ds_read_b128 v[148:151], v41
    v_mfma_f32_16x16x32_bf16 v[116:119], a[24:27], a[140:143], v[116:119]
    ds_read_b128 v[144:147], v39 offset:8720
    v_mfma_f32_16x16x32_bf16 v[108:111], a[20:23], a[140:143], v[108:111]
    buffer_load_dwordx4 v19, s[60:63], s7 offen offset:3072 lds
    v_mfma_f32_16x16x32_bf16 v[100:103], a[16:19], a[140:143], v[100:103]
    s_waitcnt vmcnt(35)
    s_add_u32 s7, s7, 28672
    s_waitcnt lgkmcnt(4)
    v_add_f32 v128, v128, v137
    v_mfma_f32_16x16x32_bf16 v[64:67], a[32:35], a[144:147], v[64:67]
    v_add_f32 v129, v129, v138
    v_mfma_f32_16x16x32_bf16 v[72:75], a[36:39], a[144:147], v[72:75]
    v_add_f32 v130, v130, v139
    v_mfma_f32_16x16x32_bf16 v[80:83], a[40:43], a[144:147], v[80:83]
    buffer_load_dwordx4 v[224:227], v34, s[64:67], s73 offen offset:0 sc1
    v_mfma_f32_16x16x32_bf16 v[88:91], a[44:47], a[144:147], v[88:91]
    s_waitcnt vmcnt(35)
    v_cvt_pk_bf16_f32 v160, v128, v129
    v_mfma_f32_16x16x32_bf16 v[92:95], a[44:47], a[148:151], v[92:95]
    v_cvt_pk_bf16_f32 v161, v130, v131
    s_waitcnt lgkmcnt(3)
    v_cvt_pk_bf16_f32 v162, v132, v133
    v_mfma_f32_16x16x32_bf16 v[84:87], a[40:43], a[148:151], v[84:87]
    v_cvt_pk_bf16_f32 v163, v134, v135
    s_waitcnt lgkmcnt(1)
    v_add_f32 v140, v140, v149
    v_mfma_f32_16x16x32_bf16 v[76:79], a[36:39], a[148:151], v[76:79]
    buffer_load_dwordx4 v[228:231], v34, s[64:67], s73 offen offset:1024 sc1
    v_mfma_f32_16x16x32_bf16 v[68:71], a[32:35], a[148:151], v[68:71]
    s_waitcnt vmcnt(35)
    v_add_f32 v141, v141, v150
    v_add_f32_e64 v142, v142, v151
    v_mfma_f32_16x16x32_bf16 v[96:99], a[32:35], a[152:155], v[96:99]
    buffer_store_dwordx4 v[160:163], v32, s[64:67], s78 offen offset:0 sc1
    v_mfma_f32_16x16x32_bf16 v[104:107], a[36:39], a[152:155], v[104:107]
    v_cvt_pk_bf16_f32 v164, v140, v141
    v_cvt_pk_bf16_f32 v165, v142, v143
    v_mfma_f32_16x16x32_bf16 v[112:115], a[40:43], a[152:155], v[112:115]
    buffer_load_dwordx4 v[232:235], v35, s[64:67], s73 offen offset:0 sc1
    v_mfma_f32_16x16x32_bf16 v[120:123], a[44:47], a[152:155], v[120:123]
    s_waitcnt vmcnt(36) lgkmcnt(0)
    v_cvt_pk_bf16_f32 v166, v144, v145
    v_cvt_pk_bf16_f32 v167, v146, v147
    v_mfma_f32_16x16x32_bf16 v[124:127], a[44:47], a[156:159], v[124:127]
    buffer_store_dwordx4 v[164:167], v32, s[64:67], s78 offen offset:128 sc1
    v_mfma_f32_16x16x32_bf16 v[116:119], a[40:43], a[156:159], v[116:119]
    v_lshrrev_b32 v56, 2, v2
    v_mfma_f32_16x16x32_bf16 v[108:111], a[36:39], a[156:159], v[108:111]
    buffer_load_dwordx4 v[236:239], v35, s[64:67], s73 offen offset:1024 sc1
    v_mfma_f32_16x16x32_bf16 v[100:103], a[32:35], a[156:159], v[100:103]
    s_waitcnt vmcnt(37)
    s_add_u32 s73, s73, 4096
    v_and_b32 v57, 3, v2
    v_mfma_f32_16x16x32_bf16 v[64:67], a[48:51], a[160:163], v[64:67]
    s_lshl_b32 s15, s3, 11
    s_add_u32 s15, s15, 25856
    v_mfma_f32_16x16x32_bf16 v[72:75], a[52:55], a[160:163], v[72:75]
    s_add_u32 m0, s9, 65536
    v_lshl_add_u32 v58, v57, 3, s15
    v_mfma_f32_16x16x32_bf16 v[80:83], a[56:59], a[160:163], v[80:83]
    buffer_load_dwordx4 v16, s[60:63], s7 offen offset:0 lds
    v_mfma_f32_16x16x32_bf16 v[88:91], a[60:63], a[160:163], v[88:91]
    s_waitcnt vmcnt(37)
    v_add_u32 v42, s15, v1
    v_mfma_f32_16x16x32_bf16 v[92:95], a[60:63], a[164:167], v[92:95]
    v_lshlrev_b32 v57, 4, v57
    v_mfma_f32_16x16x32_bf16 v[84:87], a[56:59], a[164:167], v[84:87]
    v_mul_u32_u24 v36, 896, v56
    v_mfma_f32_16x16x32_bf16 v[76:79], a[52:55], a[164:167], v[76:79]
    buffer_load_dwordx4 v17, s[60:63], s7 offen offset:1024 lds
    v_mfma_f32_16x16x32_bf16 v[68:71], a[48:51], a[164:167], v[68:71]
    s_waitcnt vmcnt(37)
    v_mul_u32_u24 v46, 80, v56
    v_mfma_f32_16x16x32_bf16 v[96:99], a[48:51], a[168:171], v[96:99]
    v_lshl_add_u32 v44, v56, 7, v57
    v_mfma_f32_16x16x32_bf16 v[104:107], a[52:55], a[168:171], v[104:107]
    v_lshl_add_u32 v43, v56, 6, v58
    v_mfma_f32_16x16x32_bf16 v[112:115], a[56:59], a[168:171], v[112:115]
    buffer_load_dwordx4 v18, s[60:63], s7 offen offset:2048 lds
    v_mfma_f32_16x16x32_bf16 v[120:123], a[60:63], a[168:171], v[120:123]
    s_waitcnt vmcnt(37)
    v_add_u32 v36, v36, v57
    v_mfma_f32_16x16x32_bf16 v[124:127], a[60:63], a[172:175], v[124:127]
    v_add3_u32 v46, v46, v57, s9
    v_mfma_f32_16x16x32_bf16 v[116:119], a[56:59], a[172:175], v[116:119]
    v_add_u32 v20, s9, v1
    v_mfma_f32_16x16x32_bf16 v[108:111], a[52:55], a[172:175], v[108:111]
    buffer_load_dwordx4 v19, s[60:63], s7 offen offset:3072 lds
    v_mfma_f32_16x16x32_bf16 v[100:103], a[48:51], a[172:175], v[100:103]
    s_waitcnt vmcnt(37)
    s_add_u32 s7, s7, 28672
    v_and_b32 v56, 15, v2
    v_mfma_f32_16x16x32_bf16 v[64:67], a[64:67], a[176:179], v[64:67]
    v_lshrrev_b32_e64 v59, 4, v2
    v_xor_b32 v21, 0x1000, v20
    v_mfma_f32_16x16x32_bf16 v[72:75], a[68:71], a[176:179], v[72:75]
    ds_read_b64_tr_b16 a[0:1], v28 offset:16384
    v_mfma_f32_16x16x32_bf16 v[80:83], a[72:75], a[176:179], v[80:83]
    v_xor_b32 v22, 0x2000, v20
    v_xor_b32 v23, 0x3000, v20
    v_mfma_f32_16x16x32_bf16 v[88:91], a[76:79], a[176:179], v[88:91]
    s_waitcnt vmcnt(36)
    v_mul_u32_u24 v56, 80, v56
    v_mfma_f32_16x16x32_bf16 v[92:95], a[76:79], a[180:183], v[92:95]
    ds_read_b64_tr_b16 a[2:3], v28 offset:18432
    v_lshl_add_u32 v59, v59, 3, s9
    v_mfma_f32_16x16x32_bf16 v[84:87], a[72:75], a[180:183], v[84:87]
    ds_read_b64_tr_b16 a[4:5], v29 offset:16384
    v_mfma_f32_16x16x32_bf16 v[76:79], a[68:71], a[180:183], v[76:79]
    v_add_u32_e64 v45, v56, v59
    v_mfma_f32_16x16x32_bf16 v[68:71], a[64:67], a[180:183], v[68:71]
    s_waitcnt vmcnt(35)
    v_and_b32 v8, 0xffff, v6
    v_lshlrev_b32_e64 v9, 16, v6
    v_mfma_f32_16x16x32_bf16 v[96:99], a[64:67], a[184:187], v[96:99]
    ds_read_b64_tr_b16 a[6:7], v29 offset:18432
    v_mfma_f32_16x16x32_bf16 v[104:107], a[68:71], a[184:187], v[104:107]
    ds_read_b64_tr_b16 a[8:9], v30 offset:16384
    v_and_b32 v10, 0xffff0000, v6
    v_mfma_f32_16x16x32_bf16 v[112:115], a[72:75], a[184:187], v[112:115]
    v_and_b32 v11, 0xffff0000, v6
    v_mfma_f32_16x16x32_bf16 v[120:123], a[76:79], a[184:187], v[120:123]
    s_waitcnt vmcnt(34)
    v_and_b32 v12, 0xffff, v7
    v_mfma_f32_16x16x32_bf16 v[124:127], a[76:79], a[188:191], v[124:127]
    ds_read_b64_tr_b16 a[10:11], v30 offset:18432
    v_lshlrev_b32 v13, 16, v7
    v_mfma_f32_16x16x32_bf16 v[116:119], a[72:75], a[188:191], v[116:119]
    ds_read_b64_tr_b16 a[12:13], v31 offset:16384
    ds_read_b64_tr_b16 a[14:15], v31 offset:18432
    v_mfma_f32_16x16x32_bf16 v[108:111], a[68:71], a[188:191], v[108:111]
    v_and_b32 v14, 0xffff0000, v7
    v_mfma_f32_16x16x32_bf16 v[100:103], a[64:67], a[188:191], v[100:103]
    s_waitcnt vmcnt(33)
    v_and_b32 v15, 0xffff0000, v7
    v_mfma_f32_16x16x32_bf16 v[64:67], a[80:83], a[192:195], v[64:67]
    v_mfma_f32_16x16x32_bf16 v[72:75], a[84:87], a[192:195], v[72:75]
    ds_read_b64_tr_b16 a[16:17], v24 offset:32768
    v_mfma_f32_16x16x32_bf16 v[80:83], a[88:91], a[192:195], v[80:83]
    buffer_load_dwordx4 v[208:211], v34, s[64:67], s73 offen offset:0 sc1
    v_mfma_f32_16x16x32_bf16 v[88:91], a[92:95], a[192:195], v[88:91]
    s_waitcnt vmcnt(33)
    v_mfma_f32_16x16x32_bf16 v[92:95], a[92:95], a[196:199], v[92:95]
    ds_read_b64_tr_b16 a[18:19], v24 offset:34816
    v_mfma_f32_16x16x32_bf16 v[84:87], a[88:91], a[196:199], v[84:87]
    ds_read_b64_tr_b16 a[20:21], v25 offset:32768
    v_mfma_f32_16x16x32_bf16 v[76:79], a[84:87], a[196:199], v[76:79]
    buffer_load_dwordx4 v[212:215], v34, s[64:67], s73 offen offset:1024 sc1
    v_mfma_f32_16x16x32_bf16 v[68:71], a[80:83], a[196:199], v[68:71]
    s_waitcnt vmcnt(33)
    v_mfma_f32_16x16x32_bf16 v[96:99], a[80:83], a[200:203], v[96:99]
    ds_read_b64_tr_b16 a[22:23], v25 offset:34816
    v_mfma_f32_16x16x32_bf16 v[104:107], a[84:87], a[200:203], v[104:107]
    ds_read_b64_tr_b16 a[24:25], v26 offset:32768
    v_mfma_f32_16x16x32_bf16 v[112:115], a[88:91], a[200:203], v[112:115]
    buffer_load_dwordx4 v[216:219], v35, s[64:67], s73 offen offset:0 sc1
    v_mfma_f32_16x16x32_bf16 v[120:123], a[92:95], a[200:203], v[120:123]
    s_waitcnt vmcnt(33)
    v_mfma_f32_16x16x32_bf16 v[124:127], a[92:95], a[204:207], v[124:127]
    ds_read_b64_tr_b16 a[26:27], v26 offset:34816
    v_mfma_f32_16x16x32_bf16 v[116:119], a[88:91], a[204:207], v[116:119]
    ds_read_b64_tr_b16 a[28:29], v27 offset:32768
    ds_read_b64_tr_b16 a[30:31], v27 offset:34816
    v_mfma_f32_16x16x32_bf16 v[108:111], a[84:87], a[204:207], v[108:111]
    buffer_load_dwordx4 v[220:223], v35, s[64:67], s73 offen offset:1024 sc1
    v_mfma_f32_16x16x32_bf16 v[100:103], a[80:83], a[204:207], v[100:103]
    s_waitcnt vmcnt(33)
    s_add_u32 s73, s73, 4096
    v_mfma_f32_16x16x32_bf16 v[64:67], a[96:99], a[208:211], v[64:67]
    s_waitcnt vmcnt(9)
    s_atomic_add s51, s[48:49], s75
    s_add_u32 m0, s9, 16384
    v_mfma_f32_16x16x32_bf16 v[72:75], a[100:103], a[208:211], v[72:75]
    ds_read_b64_tr_b16 a[32:33], v24 offset:49152
    v_mfma_f32_16x16x32_bf16 v[80:83], a[104:107], a[208:211], v[80:83]
    buffer_load_dwordx4 v16, s[60:63], s7 offen offset:0 lds
    v_mfma_f32_16x16x32_bf16 v[88:91], a[108:111], a[208:211], v[88:91]
    v_mfma_f32_16x16x32_bf16 v[92:95], a[108:111], a[212:215], v[92:95]
    ds_read_b64_tr_b16 a[34:35], v24 offset:51200
    v_mfma_f32_16x16x32_bf16 v[84:87], a[104:107], a[212:215], v[84:87]
    ds_read_b64_tr_b16 a[36:37], v25 offset:49152
    v_mfma_f32_16x16x32_bf16 v[76:79], a[100:103], a[212:215], v[76:79]
    buffer_load_dwordx4 v17, s[60:63], s7 offen offset:1024 lds
    v_mfma_f32_16x16x32_bf16 v[68:71], a[96:99], a[212:215], v[68:71]
    v_mfma_f32_16x16x32_bf16 v[96:99], a[96:99], a[216:219], v[96:99]
    ds_read_b64_tr_b16 a[38:39], v25 offset:51200
    v_mfma_f32_16x16x32_bf16 v[104:107], a[100:103], a[216:219], v[104:107]
    ds_read_b64_tr_b16 a[40:41], v26 offset:49152
    v_mfma_f32_16x16x32_bf16 v[112:115], a[104:107], a[216:219], v[112:115]
    buffer_load_dwordx4 v18, s[60:63], s7 offen offset:2048 lds
    v_mfma_f32_16x16x32_bf16 v[120:123], a[108:111], a[216:219], v[120:123]
    v_mfma_f32_16x16x32_bf16 v[124:127], a[108:111], a[220:223], v[124:127]
    ds_read_b64_tr_b16 a[42:43], v26 offset:51200
    v_mfma_f32_16x16x32_bf16 v[116:119], a[104:107], a[220:223], v[116:119]
    ds_read_b64_tr_b16 a[44:45], v27 offset:49152
    ds_read_b64_tr_b16 a[46:47], v27 offset:51200
    v_mfma_f32_16x16x32_bf16 v[108:111], a[100:103], a[220:223], v[108:111]
    buffer_load_dwordx4 v19, s[60:63], s7 offen offset:3072 lds
    v_mfma_f32_16x16x32_bf16 v[100:103], a[96:99], a[220:223], v[100:103]
    s_waitcnt lgkmcnt(14)
    v_mfma_f32_16x16x32_bf16 v[64:67], a[0:3], a[224:227], v[64:67]
    v_mfma_f32_16x16x32_bf16 v[72:75], a[4:7], a[224:227], v[72:75]
    ds_read_b64_tr_b16 a[48:49], v28 offset:32768
    v_mfma_f32_16x16x32_bf16 v[80:83], a[8:11], a[224:227], v[80:83]
    buffer_load_dwordx4 v[192:195], v34, s[64:67], s73 offen offset:0 sc1
    v_mfma_f32_16x16x32_bf16 v[88:91], a[12:15], a[224:227], v[88:91]
    v_mfma_f32_16x16x32_bf16 v[92:95], a[12:15], a[228:231], v[92:95]
    ds_read_b64_tr_b16 a[50:51], v28 offset:34816
    v_mfma_f32_16x16x32_bf16 v[84:87], a[8:11], a[228:231], v[84:87]
    ds_read_b64_tr_b16 a[52:53], v29 offset:32768
    v_mfma_f32_16x16x32_bf16 v[76:79], a[4:7], a[228:231], v[76:79]
    buffer_load_dwordx4 v[196:199], v34, s[64:67], s73 offen offset:1024 sc1
    v_mfma_f32_16x16x32_bf16 v[68:71], a[0:3], a[228:231], v[68:71]
    v_mfma_f32_16x16x32_bf16 v[96:99], a[0:3], a[232:235], v[96:99]
    ds_read_b64_tr_b16 a[54:55], v29 offset:34816
    v_mfma_f32_16x16x32_bf16 v[104:107], a[4:7], a[232:235], v[104:107]
    ds_read_b64_tr_b16 a[56:57], v30 offset:32768
    v_mfma_f32_16x16x32_bf16 v[112:115], a[8:11], a[232:235], v[112:115]
    buffer_load_dwordx4 v[200:203], v35, s[64:67], s73 offen offset:0 sc1
    v_mfma_f32_16x16x32_bf16 v[120:123], a[12:15], a[232:235], v[120:123]
    v_mfma_f32_16x16x32_bf16 v[124:127], a[12:15], a[236:239], v[124:127]
    ds_read_b64_tr_b16 a[58:59], v30 offset:34816
    v_mfma_f32_16x16x32_bf16 v[116:119], a[8:11], a[236:239], v[116:119]
    ds_read_b64_tr_b16 a[60:61], v31 offset:32768
    ds_read_b64_tr_b16 a[62:63], v31 offset:34816
    v_mfma_f32_16x16x32_bf16 v[108:111], a[4:7], a[236:239], v[108:111]
    buffer_load_dwordx4 v[204:207], v35, s[64:67], s73 offen offset:1024 sc1
    v_mfma_f32_16x16x32_bf16 v[100:103], a[0:3], a[236:239], v[100:103]
    s_waitcnt lgkmcnt(14)
    s_add_u32 s73, s73, 4096
    v_mfma_f32_16x16x32_bf16 v[80:83], a[24:27], a[240:243], v[80:83]
    v_mfma_f32_16x16x32_bf16 v[88:91], a[28:31], a[240:243], v[88:91]
    ds_read_b64_tr_b16 a[64:65], v24 offset:0
    v_mfma_f32_16x16x32_bf16 v[92:95], a[28:31], a[244:247], v[92:95]
    buffer_load_dwordx4 v[176:179], v34, s[64:67], s73 offen offset:0 sc1
    v_mfma_f32_16x16x32_bf16 v[84:87], a[24:27], a[244:247], v[84:87]
    ds_read_b64_tr_b16 a[66:67], v24 offset:2048
    v_mfma_f32_16x16x32_bf16 v[96:99], a[16:19], a[248:251], v[96:99]
    ds_read_b64_tr_b16 a[68:69], v25 offset:0
    v_mfma_f32_16x16x32_bf16 v[104:107], a[20:23], a[248:251], v[104:107]
    buffer_load_dwordx4 v[180:183], v34, s[64:67], s73 offen offset:1024 sc1
    v_mfma_f32_16x16x32_bf16 v[112:115], a[24:27], a[248:251], v[112:115]
    ds_read_b64_tr_b16 a[70:71], v25 offset:2048
    v_mfma_f32_16x16x32_bf16 v[120:123], a[28:31], a[248:251], v[120:123]
    ds_read_b64_tr_b16 a[72:73], v26 offset:0
    v_mfma_f32_16x16x32_bf16 v[124:127], a[28:31], a[252:255], v[124:127]
    buffer_load_dwordx4 v[184:187], v35, s[64:67], s73 offen offset:0 sc1
    v_mfma_f32_16x16x32_bf16 v[116:119], a[24:27], a[252:255], v[116:119]
    ds_read_b64_tr_b16 a[74:75], v26 offset:2048
    v_mfma_f32_16x16x32_bf16 v[108:111], a[20:23], a[252:255], v[108:111]
    ds_read_b64_tr_b16 a[76:77], v27 offset:0
    ds_read_b64_tr_b16 a[78:79], v27 offset:2048
    v_mfma_f32_16x16x32_bf16 v[100:103], a[16:19], a[252:255], v[100:103]
    s_waitcnt lgkmcnt(14)
    buffer_load_dwordx4 v[188:191], v35, s[64:67], s73 offen offset:1024 sc1
    v_mfma_f32_16x16x32_bf16 v[80:83], a[40:43], v[240:243], v[80:83]
    s_waitcnt vmcnt(16)
    v_mfma_f32_16x16x32_bf16 v[88:91], a[44:47], v[240:243], v[88:91]
    ds_read_b64_tr_b16 a[80:81], v28 offset:0
    v_mfma_f32_16x16x32_bf16 v[92:95], a[44:47], v[244:247], v[92:95]
    v_mfma_f32_16x16x32_bf16 v[84:87], a[40:43], v[244:247], v[84:87]
    ds_read_b64_tr_b16 a[82:83], v28 offset:2048
    v_mfma_f32_16x16x32_bf16 v[96:99], a[32:35], v[248:251], v[96:99]
    ds_read_b64_tr_b16 a[84:85], v29 offset:0
    v_mfma_f32_16x16x32_bf16 v[104:107], a[36:39], v[248:251], v[104:107]
    s_mov_b32 s99, 0
    v_mfma_f32_16x16x32_bf16 v[112:115], a[40:43], v[248:251], v[112:115]
    ds_read_b64_tr_b16 a[86:87], v29 offset:2048
    v_mfma_f32_16x16x32_bf16 v[120:123], a[44:47], v[248:251], v[120:123]
    ds_read_b64_tr_b16 a[88:89], v30 offset:0
    v_mfma_f32_16x16x32_bf16 v[124:127], a[44:47], v[252:255], v[124:127]
    v_mfma_f32_16x16x32_bf16 v[116:119], a[40:43], v[252:255], v[116:119]
    ds_read_b64_tr_b16 a[90:91], v30 offset:2048
    v_mfma_f32_16x16x32_bf16 v[108:111], a[36:39], v[252:255], v[108:111]
    ds_read_b64_tr_b16 a[92:93], v31 offset:0
    ds_read_b64_tr_b16 a[94:95], v31 offset:2048
    v_mfma_f32_16x16x32_bf16 v[100:103], a[32:35], v[252:255], v[100:103]
    s_waitcnt lgkmcnt(14)
    v_mfma_f32_16x16x32_bf16 v[80:83], a[56:59], v[224:227], v[80:83]
    s_waitcnt vmcnt(8)
    v_mfma_f32_16x16x32_bf16 v[88:91], a[60:63], v[224:227], v[88:91]
    ds_read_b64_tr_b16 a[96:97], v24 offset:16384
    v_mfma_f32_16x16x32_bf16 v[92:95], a[60:63], v[228:231], v[92:95]
    v_mfma_f32_16x16x32_bf16 v[84:87], a[56:59], v[228:231], v[84:87]
    ds_read_b64_tr_b16 a[98:99], v24 offset:18432
    v_mfma_f32_16x16x32_bf16 v[96:99], a[48:51], v[232:235], v[96:99]
    ds_read_b64_tr_b16 a[100:101], v25 offset:16384
    v_mfma_f32_16x16x32_bf16 v[104:107], a[52:55], v[232:235], v[104:107]
    v_mfma_f32_16x16x32_bf16 v[112:115], a[56:59], v[232:235], v[112:115]
    ds_read_b64_tr_b16 a[102:103], v25 offset:18432
    v_mfma_f32_16x16x32_bf16 v[120:123], a[60:63], v[232:235], v[120:123]
    ds_read_b64_tr_b16 a[104:105], v26 offset:16384
    v_mfma_f32_16x16x32_bf16 v[124:127], a[60:63], v[236:239], v[124:127]
    v_mfma_f32_16x16x32_bf16 v[116:119], a[56:59], v[236:239], v[116:119]
    ds_read_b64_tr_b16 a[106:107], v26 offset:18432
    v_mfma_f32_16x16x32_bf16 v[108:111], a[52:55], v[236:239], v[108:111]
    s_load_dword s99, s[48:49], s77
    ds_read_b64_tr_b16 a[108:109], v27 offset:16384
    ds_read_b64_tr_b16 a[110:111], v27 offset:18432
    v_mfma_f32_16x16x32_bf16 v[100:103], a[48:51], v[236:239], v[100:103]
    s_waitcnt lgkmcnt(14)
L_st6:
    s_cbranch_execz L_hopret
    v_mfma_f32_16x16x32_bf16 v[80:83], a[72:75], v[208:211], v[80:83]
    v_mfma_f32_16x16x32_bf16 v[88:91], a[76:79], v[208:211], v[88:91]
    v_mfma_f32_16x16x32_bf16 v[92:95], a[76:79], v[212:215], v[92:95]
    v_mfma_f32_16x16x32_bf16 v[84:87], a[72:75], v[212:215], v[84:87]
    v_mfma_f32_16x16x32_bf16 v[96:99], a[64:67], v[216:219], v[96:99]
    v_mfma_f32_16x16x32_bf16 v[104:107], a[68:71], v[216:219], v[104:107]
    v_mfma_f32_16x16x32_bf16 v[112:115], a[72:75], v[216:219], v[112:115]
    v_mfma_f32_16x16x32_bf16 v[120:123], a[76:79], v[216:219], v[120:123]
    v_mfma_f32_16x16x32_bf16 v[124:127], a[76:79], v[220:223], v[124:127]
    v_mfma_f32_16x16x32_bf16 v[116:119], a[72:75], v[220:223], v[116:119]
    v_mfma_f32_16x16x32_bf16 v[108:111], a[68:71], v[220:223], v[108:111]
    v_mfma_f32_16x16x32_bf16 v[100:103], a[64:67], v[220:223], v[100:103]
    s_waitcnt vmcnt(7) lgkmcnt(10)
    v_mfma_f32_16x16x32_bf16 v[80:83], a[88:91], v[192:195], v[80:83]
    s_waitcnt lgkmcnt(8)
    v_mfma_f32_16x16x32_bf16 v[88:91], a[92:95], v[192:195], v[88:91]
    s_waitcnt vmcnt(6)
    v_mfma_f32_16x16x32_bf16 v[92:95], a[92:95], v[196:199], v[92:95]
    v_mfma_f32_16x16x32_bf16 v[84:87], a[88:91], v[196:199], v[84:87]
    s_waitcnt vmcnt(3) lgkmcnt(2)
    v_mfma_f32_16x16x32_bf16 v[80:83], a[104:107], v[176:179], v[80:83]
    ds_read_b32 v3, v1
    ds_read_b32 v3, v1
    s_waitcnt lgkmcnt(2)
    v_mfma_f32_16x16x32_bf16 v[88:91], a[108:111], v[176:179], v[88:91]
    s_waitcnt vmcnt(2)
    v_mfma_f32_16x16x32_bf16 v[92:95], a[108:111], v[180:183], v[92:95]
    v_mfma_f32_16x16x32_bf16 v[84:87], a[104:107], v[180:183], v[84:87]
    v_mfma_f32_16x16x32_bf16 v[96:99], a[80:83], v[200:203], v[96:99]
    v_mfma_f32_16x16x32_bf16 v[104:107], a[84:87], v[200:203], v[104:107]
    v_mfma_f32_16x16x32_bf16 v[108:111], a[84:87], v[204:207], v[108:111]
    ds_write_b128 v20, v[80:83] offset:0
    v_mfma_f32_16x16x32_bf16 v[100:103], a[80:83], v[204:207], v[100:103]
    s_waitcnt vmcnt(1)
    v_mfma_f32_16x16x32_bf16 v[96:99], a[96:99], v[184:187], v[96:99]
    s_nop 0
    ds_write_b128 v20, v[84:87] offset:1024
    v_mfma_f32_16x16x32_bf16 v[104:107], a[100:103], v[184:187], v[104:107]
    s_waitcnt vmcnt(0)
    v_mfma_f32_16x16x32_bf16 v[108:111], a[100:103], v[188:191], v[108:111]
    ds_write_b128 v20, v[88:91] offset:2048
    v_mfma_f32_16x16x32_bf16 v[100:103], a[96:99], v[188:191], v[100:103]
    v_mfma_f32_16x16x32_bf16 v[112:115], a[88:91], v[200:203], v[112:115]
    ds_write_b128 v20, v[92:95] offset:3072
    v_mfma_f32_16x16x32_bf16 v[120:123], a[92:95], v[200:203], v[120:123]
    v_mfma_f32_16x16x32_bf16 v[124:127], a[92:95], v[204:207], v[124:127]
    ds_write_b128 v20, v[96:99] offset:16384
    v_mfma_f32_16x16x32_bf16 v[116:119], a[88:91], v[204:207], v[116:119]
    v_mfma_f32_16x16x32_bf16 v[112:115], a[104:107], v[184:187], v[112:115]
    s_nop 0
    ds_write_b128 v20, v[100:103] offset:17408
    v_mfma_f32_16x16x32_bf16 v[120:123], a[108:111], v[184:187], v[120:123]
    v_mfma_f32_16x16x32_bf16 v[124:127], a[108:111], v[188:191], v[124:127]
    ds_write_b128 v20, v[104:107] offset:18432
    v_mfma_f32_16x16x32_bf16 v[116:119], a[104:107], v[188:191], v[116:119]
    v_mfma_f32_16x16x32_bf16 v[64:67], a[16:19], a[240:243], v[64:67]
    ds_write_b128 v20, v[108:111] offset:19456
    s_cmp_lt_u32 s99, 16
    s_cbranch_scc1 L_slow3
L_back3:
    v_mfma_f32_16x16x32_bf16 v[72:75], a[20:23], a[240:243], v[72:75]
    s_lshl_b32 s0, s3, 11
    s_add_u32 m0, s0, 25856
    s_nop 0
    buffer_load_dwordx4 v44, s[64:67], s79 offen sc1 lds
    v_mfma_f32_16x16x32_bf16 v[76:79], a[20:23], a[244:247], v[76:79]
    s_add_u32 m0, s0, 24832
    ds_write_b128 v20, v[112:115] offset:32768
    v_mfma_f32_16x16x32_bf16 v[68:71], a[16:19], a[244:247], v[68:71]
    buffer_load_dwordx4 v44, s[64:67], s79 offen offset:2048 sc1 lds
    v_mfma_f32_16x16x32_bf16 v[64:67], a[32:35], v[240:243], v[64:67]
    v_mfma_f32_16x16x32_bf16 v[72:75], a[36:39], v[240:243], v[72:75]
    ds_write_b128 v20, v[116:119] offset:33792
    v_mfma_f32_16x16x32_bf16 v[76:79], a[36:39], v[244:247], v[76:79]
    v_mfma_f32_16x16x32_bf16 v[68:71], a[32:35], v[244:247], v[68:71]
    v_mfma_f32_16x16x32_bf16 v[64:67], a[48:51], v[224:227], v[64:67]
    ds_write_b128 v20, v[120:123] offset:34816
    v_mfma_f32_16x16x32_bf16 v[72:75], a[52:55], v[224:227], v[72:75]
    v_mfma_f32_16x16x32_bf16 v[76:79], a[52:55], v[228:231], v[76:79]
    v_mfma_f32_16x16x32_bf16 v[68:71], a[48:51], v[228:231], v[68:71]
    ds_write_b128 v20, v[124:127] offset:35840
    v_mfma_f32_16x16x32_bf16 v[64:67], a[64:67], v[208:211], v[64:67]
    v_mfma_f32_16x16x32_bf16 v[72:75], a[68:71], v[208:211], v[72:75]
    v_mfma_f32_16x16x32_bf16 v[76:79], a[68:71], v[212:215], v[76:79]
    ds_read_b32 v3, v1
    s_waitcnt lgkmcnt(1)
    s_barrier
    ds_read_b128 v[128:131], v21 offset:0
    v_mfma_f32_16x16x32_bf16 v[68:71], a[64:67], v[212:215], v[68:71]
    ds_read_b128 v[144:147], v22 offset:16384
    v_mfma_f32_16x16x32_bf16 v[64:67], a[80:83], v[192:195], v[64:67]
    ds_read_b128 v[160:163], v23 offset:32768
    v_mfma_f32_16x16x32_bf16 v[72:75], a[84:87], v[192:195], v[72:75]
    ds_read_b128 v[132:135], v21 offset:1024
    v_mfma_f32_16x16x32_bf16 v[76:79], a[84:87], v[196:199], v[76:79]
    ds_read_b128 v[148:151], v22 offset:17408
    v_mfma_f32_16x16x32_bf16 v[68:71], a[80:83], v[196:199], v[68:71]
    ds_read_b128 v[164:167], v23 offset:33792
    v_mfma_f32_16x16x32_bf16 v[64:67], a[96:99], v[176:179], v[64:67]
    ds_read_b128 v[136:139], v21 offset:2048
    v_mfma_f32_16x16x32_bf16 v[72:75], a[100:103], v[176:179], v[72:75]
    ds_read_b128 v[152:155], v22 offset:18432
    v_mfma_f32_16x16x32_bf16 v[76:79], a[100:103], v[180:183], v[76:79]
    ds_read_b128 v[168:171], v23 offset:34816
    v_mfma_f32_16x16x32_bf16 v[68:71], a[96:99], v[180:183], v[68:71]
    ds_read_b128 v[140:143], v21 offset:3072
    ds_read_b128 v[156:159], v22 offset:19456
    ds_read_b128 v[172:175], v23 offset:35840
    s_waitcnt lgkmcnt(11)
    v_pk_add_f32 v[64:65], v[64:65], v[128:129]
    s_waitcnt lgkmcnt(9)
    v_pk_add_f32 v[144:145], v[144:145], v[160:161]
    v_pk_add_f32 v[66:67], v[66:67], v[130:131]
    v_pk_add_f32 v[146:147], v[146:147], v[162:163]
    v_pk_add_f32 v[64:65], v[64:65], v[144:145]
    s_waitcnt lgkmcnt(8)
    v_pk_add_f32 v[68:69], v[68:69], v[132:133]
    v_pk_add_f32 v[66:67], v[66:67], v[146:147]
    v_pk_mul_f32 v[64:65], v[64:65], v[10:11]
    v_pk_add_f32 v[70:71], v[70:71], v[134:135]
    v_pk_mul_f32 v[66:67], v[66:67], v[10:11]
    s_waitcnt lgkmcnt(6)
    v_pk_add_f32 v[148:149], v[148:149], v[164:165]
    v_pk_add_f32 v[150:151], v[150:151], v[166:167]
    v_pk_add_f32 v[68:69], v[68:69], v[148:149]
    s_nop 0
    v_pk_add_f32 v[70:71], v[70:71], v[150:151]
    s_waitcnt lgkmcnt(5)
    v_pk_add_f32 v[72:73], v[72:73], v[136:137]
    v_pk_mul_f32 v[68:69], v[68:69], v[14:15]
    s_nop 0
    v_pk_mul_f32 v[70:71], v[70:71], v[14:15]
    v_pk_add_f32 v[74:75], v[74:75], v[138:139]
    s_waitcnt lgkmcnt(3)
    v_pk_add_f32 v[152:153], v[152:153], v[168:169]
    s_nop 0
    v_pk_add_f32 v[154:155], v[154:155], v[170:171]
    v_pk_add_f32 v[72:73], v[72:73], v[152:153]
    v_pk_add_f32 v[74:75], v[74:75], v[154:155]
    s_waitcnt lgkmcnt(2)
    s_nop 0
    v_pk_add_f32 v[76:77], v[76:77], v[140:141]
    s_waitcnt vmcnt(0)
    v_pk_mul_f32 v[72:73], v[72:73], v[10:11]
    v_pk_mul_f32 v[74:75], v[74:75], v[10:11]
    s_nop 0
    ds_read_b32 v3, v1
    s_waitcnt lgkmcnt(1)
    v_pk_add_f32 v[156:157], v[156:157], v[172:173]
    v_pk_add_f32 v[78:79], v[78:79], v[142:143]
    s_nop 0
    v_pk_add_f32 v[158:159], v[158:159], v[174:175]
    v_pk_add_f32 v[76:77], v[76:77], v[156:157]
    v_pk_add_f32 v[78:79], v[78:79], v[158:159]
    v_pk_mul_f32 v[76:77], v[76:77], v[14:15]
    v_pk_mul_f32 v[78:79], v[78:79], v[14:15]
    ds_read_b64_tr_b16 v[56:57], v43 offset:0
    ds_read_b64_tr_b16 v[58:59], v43 offset:32
    ds_read_b64_tr_b16 v[60:61], v43 offset:1024
    ds_read_b64_tr_b16 v[62:63], v43 offset:1056
    s_add_u32 s14, s81, 14336
    s_waitcnt lgkmcnt(3)
    v_dot2_f32_bf16 v64, v56, v8, v64
    s_nop 0
    v_dot2_f32_bf16 v65, v56, v9, v65
    v_dot2_f32_bf16 v66, v57, v8, v66
    v_dot2_f32_bf16 v67, v57, v9, v67
    s_nop 0
    s_nop 0
    v_cvt_pk_bf16_f32 v48, v64, v65
    s_waitcnt lgkmcnt(2)
    v_dot2_f32_bf16 v68, v58, v12, v68
    v_cvt_pk_bf16_f32 v49, v66, v67
    s_nop 0
    v_dot2_f32_bf16 v69, v58, v13, v69
    v_dot2_f32_bf16 v70, v59, v12, v70
    v_dot2_f32_bf16 v71, v59, v13, v71
    s_nop 0
    s_nop 0
    v_cvt_pk_bf16_f32 v50, v68, v69
    s_waitcnt lgkmcnt(1)
    v_dot2_f32_bf16 v72, v60, v8, v72
    v_cvt_pk_bf16_f32 v51, v70, v71
    s_nop 0
    v_dot2_f32_bf16 v73, v60, v9, v73
    v_dot2_f32_bf16 v74, v61, v8, v74
    v_dot2_f32_bf16 v75, v61, v9, v75
    s_nop 0
    s_nop 0
    v_cvt_pk_bf16_f32 v52, v72, v73
    ds_read_b32 v3, v1
    s_waitcnt lgkmcnt(1)
    v_dot2_f32_bf16 v76, v62, v12, v76
    s_nop 0
    v_cvt_pk_bf16_f32 v53, v74, v75
    v_dot2_f32_bf16 v77, v62, v13, v77
    v_dot2_f32_bf16 v78, v63, v12, v78
    v_dot2_f32_bf16 v79, v63, v13, v79
    s_nop 0
    v_cvt_pk_bf16_f32 v54, v76, v77
    s_nop 0
    v_cvt_pk_bf16_f32 v55, v78, v79
    ds_write_b64 v45, v[48:49] offset:49152
    ds_write_b64 v45, v[50:51] offset:50432
    ds_write_b64 v45, v[52:53] offset:49184
    ds_write_b64 v45, v[54:55] offset:50464
    ds_read_b128 v[128:131], v46 offset:49152
    ds_read_b128 v[132:135], v46 offset:50432
    s_waitcnt lgkmcnt(1)
    buffer_store_dwordx4 v[128:131], v36, s[68:71], s81 offen sc0 sc1
    ds_read_b32 v3, v1
    s_waitcnt lgkmcnt(1)
    buffer_store_dwordx4 v[132:135], v36, s[68:71], s14 offen sc0 sc1
L_end:
    s_endpgm
L_slow0:

    s_mov_b32 s50, 0
    s_waitcnt lgkmcnt(0)
    s_cmp_ge_u32 s99, 32
    s_cbranch_scc1 L_back0
    v_mov_b32 v5, 128
L_spin0:
    s_add_u32 s50, s50, 1
    s_cmp_gt_u32 s50, 0x40000
    s_cbranch_scc1 L_back0
    global_load_dword v4, v5, s[46:47] sc1
    s_waitcnt vmcnt(0)
    v_readfirstlane_b32 s99, v4
    s_nop 0
    s_cmp_ge_u32 s99, 32
    s_cbranch_scc1 L_back0

    s_branch L_spin0
L_slow1:

    s_mov_b32 s50, 0
    s_waitcnt lgkmcnt(0)
    s_cmp_ge_u32 s99, 7
    s_cbranch_scc1 L_back1
    v_mov_b32 v5, s76
L_spin1:
    s_add_u32 s50, s50, 1
    s_cmp_gt_u32 s50, 0x40000
    s_cbranch_scc1 L_back1
    s_mov_b32 s99, 0
    s_atomic_add s99, s[48:49], s76 glc
    s_waitcnt lgkmcnt(0)
    s_cmp_ge_u32 s99, 7
    s_cbranch_scc1 L_back1

    s_branch L_spin1
L_slow2:

    s_mov_b32 s50, 0
    s_waitcnt lgkmcnt(0)
    s_cmp_ge_u32 s99, 7
    s_cbranch_scc1 L_back2
    v_mov_b32 v5, s76
L_spin2:
    s_add_u32 s50, s50, 1
    s_cmp_gt_u32 s50, 0x40000
    s_cbranch_scc1 L_back2
    s_mov_b32 s99, 0
    s_atomic_add s99, s[48:49], s76 glc
    s_waitcnt lgkmcnt(0)
    s_cmp_ge_u32 s99, 7
    s_cbranch_scc1 L_back2

    s_branch L_spin2
L_slow3:

    s_mov_b32 s50, 0
    s_waitcnt lgkmcnt(0)
    s_cmp_ge_u32 s99, 16
    s_cbranch_scc1 L_back3
    v_mov_b32 v5, s77
L_spin3:
    s_add_u32 s50, s50, 1
    s_cmp_gt_u32 s50, 0x40000
    s_cbranch_scc1 L_back3
    s_mov_b32 s99, 0
    s_atomic_add s99, s[48:49], s77 glc
    s_waitcnt lgkmcnt(0)
    s_cmp_ge_u32 s99, 16
    s_cbranch_scc1 L_back3

    s_branch L_spin3
L_helper:
    s_load_dwordx2 s[48:49], s[0:1], 128
    s_waitcnt lgkmcnt(0)
    v_lshrrev_b32 v3, 6, v0
    v_and_b32 v2, 63, v0
    s_mul_i32 s6, s2, 57344
    v_readfirstlane_b32 s3, v3
    v_lshlrev_b32 v1, 4, v2
    v_mov_b32 v8, 0
    s_mul_i32 s7, s3, 14336
    s_add_u32 s8, s6, s7
    s_mov_b32 s52, s16
    s_mov_b32 s53, s17
    s_mov_b32 s54, 1835008
    s_mov_b32 s55, 0x20000
    s_mov_b32 s56, s42
    s_mov_b32 s57, s43
    s_mov_b32 s58, 896
    s_mov_b32 s59, 0x20000
    s_mov_b32 s64, s48
    s_mov_b32 s65, s49
    s_mov_b32 s66, 13631488
    s_mov_b32 s67, 0x20000
    s_mov_b32 s68, s46
    s_mov_b32 s69, s47
    s_mov_b32 s70, 256
    s_mov_b32 s71, 0x20000
    v_mov_b32 v9, 0
    v_mov_b32 v10, 0
    v_mov_b32 v11, 0
    v_cmp_gt_u32 vcc, 40, v0
    v_mov_b32 v4, 0x80000000
    v_lshrrev_b32 v5, 2, v0
    s_mul_i32 s9, s2, 2560
    s_add_u32 s9, s9, 11534336
    v_mul_u32_u24 v5, 192, v5
    v_min_u32 v24, 195, v0
    s_mul_i32 s14, s2, 50176
    v_add_u32 v5, v5, v1
    v_mul_u32_u24 v25, 4682, v24
    v_lshlrev_b32 v24, 7, v24
    v_cndmask_b32 v5, v4, v5, vcc
    v_lshrrev_b32 v25, 16, v25
    v_min_u32 v31, 1, v0
    v_mul_u32_u24 v25, 1792, v25
    v_lshlrev_b32 v31, 31, v31
    v_add3_u32 v25, v25, v24, s14
    s_lshr_b32 s14, s14, 1
    v_add_u32 v24, s14, v24
    s_lshl_b32 s15, s2, 2
    s_add_u32 m0, s7, 0
    buffer_store_dwordx4 v[8:11], v5, s[64:67], s9 offen sc1
    global_load_dword v27, v25, s[36:37] offset:1792
    v_add_u32 v26, 802816, v24
    v_mov_b32 v9, 1
    s_add_u32 s9, s8, 0
    v_lshrrev_b32 v6, 4, v2
    v_bfe_u32 v7, v2, 2, 2
    v_and_b32 v12, 3, v2
    v_and_b32 v13, 15, v2
    v_lshl_add_u32 v7, v6, 3, v7
    v_mul_u32_u24 v14, 144, v13
    v_mul_u32_u24 v7, 896, v7
    v_lshrrev_b32 v15, 3, v2
    v_lshl_add_u32 v14, v6, 4, v14
    v_lshl_add_u32 v15, v15, 4, v1
    v_mul_u32_u24 v16, 896, v13
    v_lshl_add_u32 v16, v6, 4, v16
    v_add_u32 v16, s7, v16
    v_lshlrev_b32 v17, 4, v6
    v_cmp_gt_u32 vcc, 16, v2
    v_lshlrev_b32 v18, 2, v2
    s_nop 0
    v_cndmask_b32 v18, v4, v18, vcc
    buffer_load_dwordx4 v1, s[52:55], s9 offen offset:0 lds
    buffer_load_dwordx4 v1, s[52:55], s9 offen offset:1024 lds
    buffer_load_dwordx4 v1, s[52:55], s9 offen offset:2048 lds
    buffer_load_dwordx4 v1, s[52:55], s9 offen offset:3072 lds
    s_add_u32 m0, s7, 4096
    s_add_u32 s9, s8, 4096
    buffer_load_dwordx4 v1, s[52:55], s9 offen offset:0 lds
    buffer_load_dwordx4 v1, s[52:55], s9 offen offset:1024 lds
    buffer_load_dwordx4 v1, s[52:55], s9 offen offset:2048 lds
    buffer_load_dwordx4 v1, s[52:55], s9 offen offset:3072 lds
    s_add_u32 m0, s7, 8192
    s_add_u32 s9, s8, 8192
    buffer_load_dwordx4 v1, s[52:55], s9 offen offset:0 lds
    buffer_load_dwordx4 v1, s[52:55], s9 offen offset:1024 lds
    buffer_load_dwordx4 v1, s[52:55], s9 offen offset:2048 lds
    buffer_load_dwordx4 v1, s[52:55], s9 offen offset:3072 lds
    s_add_u32 m0, s7, 12288
    s_add_u32 s9, s8, 12288
    buffer_load_dwordx4 v1, s[52:55], s9 offen offset:0 lds
    buffer_load_dwordx4 v1, s[52:55], s9 offen offset:1024 lds
    s_mov_b32 m0, 57344
    s_nop 0
    buffer_load_dwordx4 v1, s[56:59], 0 offen lds
    s_barrier
    global_load_dword v28, v25, s[38:39] offset:1792
    s_mul_i32 s9, s3, 224
    v_lshl_add_u32 v12, v12, 3, s9
    s_waitcnt vmcnt(1)
    s_mul_i32 s10, s3, 16128
    s_add_u32 s10, s10, 59392
    v_add_u32 v12, v12, v7
    v_add_u32 v14, s10, v14
    v_add_u32 v15, s10, v15
    s_add_u32 s11, s8, 262144
    s_lshl2_add_u32 s13, s2, s3
    s_lshl_b32 s13, s13, 6
    s_add_u32 s13, s13, 16384
    s_barrier
    ds_read_b64_tr_b16 v[128:129], v12 offset:0
    ds_read_b64_tr_b16 v[130:131], v12 offset:3584
    ds_read_b64_tr_b16 v[132:133], v12 offset:28672
    ds_read_b64_tr_b16 v[134:135], v12 offset:32256
    ds_read_b64_tr_b16 v[136:137], v12 offset:32
    ds_read_b64_tr_b16 v[138:139], v12 offset:3616
    ds_read_b64_tr_b16 v[140:141], v12 offset:28704
    ds_read_b64_tr_b16 v[142:143], v12 offset:32288
    ds_read_b64_tr_b16 v[144:145], v12 offset:64
    ds_read_b64_tr_b16 v[146:147], v12 offset:3648
    ds_read_b64_tr_b16 v[148:149], v12 offset:28736
    ds_read_b64_tr_b16 v[150:151], v12 offset:32320
    ds_read_b64_tr_b16 v[152:153], v12 offset:96
    ds_read_b64_tr_b16 v[154:155], v12 offset:3680
    ds_read_b64_tr_b16 v[156:157], v12 offset:28768
    ds_read_b64_tr_b16 v[158:159], v12 offset:32352
    ds_read_b64_tr_b16 v[160:161], v12 offset:128
    ds_read_b64_tr_b16 v[162:163], v12 offset:3712
    ds_read_b64_tr_b16 v[164:165], v12 offset:28800
    ds_read_b64_tr_b16 v[166:167], v12 offset:32384
    ds_read_b64_tr_b16 v[168:169], v12 offset:160
    ds_read_b64_tr_b16 v[170:171], v12 offset:3744
    ds_read_b64_tr_b16 v[172:173], v12 offset:28832
    ds_read_b64_tr_b16 v[174:175], v12 offset:32416
    ds_read_b64_tr_b16 v[176:177], v12 offset:192
    ds_read_b64_tr_b16 v[178:179], v12 offset:3776
    ds_read_b64_tr_b16 v[180:181], v12 offset:28864
    ds_read_b64_tr_b16 v[182:183], v12 offset:32448
    s_waitcnt lgkmcnt(14)
    ds_write_b128 v14, v[128:131] offset:0
    ds_write_b128 v14, v[132:135] offset:64
    ds_read_b128 v[192:195], v15 offset:0
    ds_read_b128 v[196:199], v15 offset:1152
    ds_write_b128 v14, v[136:139] offset:2304
    ds_write_b128 v14, v[140:143] offset:2368
    ds_read_b128 v[200:203], v15 offset:2304
    ds_read_b128 v[204:207], v15 offset:3456
    ds_write_b128 v14, v[144:147] offset:4608
    ds_write_b128 v14, v[148:151] offset:4672
    ds_read_b128 v[208:211], v15 offset:4608
    ds_read_b128 v[212:215], v15 offset:5760
    ds_write_b128 v14, v[152:155] offset:6912
    s_waitcnt lgkmcnt(14)
    ds_write_b128 v14, v[156:159] offset:6976
    ds_read_b128 v[216:219], v15 offset:6912
    ds_read_b128 v[220:223], v15 offset:8064
    ds_write_b128 v14, v[160:163] offset:9216
    ds_write_b128 v14, v[164:167] offset:9280
    ds_read_b128 v[224:227], v15 offset:9216
    ds_read_b128 v[228:231], v15 offset:10368
    ds_write_b128 v14, v[168:171] offset:11520
    ds_write_b128 v14, v[172:175] offset:11584
    ds_read_b128 v[232:235], v15 offset:11520
    ds_read_b128 v[236:239], v15 offset:12672
    ds_write_b128 v14, v[176:179] offset:13824
    s_waitcnt lgkmcnt(14)
    ds_write_b128 v14, v[180:183] offset:13888
    ds_read_b128 v[240:243], v15 offset:13824
    ds_read_b128 v[244:247], v15 offset:14976
    buffer_store_dwordx4 v[192:195], v1, s[64:67], s11 offen offset:0 sc1
    buffer_store_dwordx4 v[196:199], v1, s[64:67], s11 offen offset:1024 sc1
    ds_read_b128 v[64:67], v17 offset:57344
    ds_read_b128 v[68:71], v16 offset:0
    s_add_u32 s11, s11, 2048
    buffer_store_dwordx4 v[200:203], v1, s[64:67], s11 offen offset:0 sc1
    buffer_store_dwordx4 v[204:207], v1, s[64:67], s11 offen offset:1024 sc1
    s_add_u32 s11, s11, 2048
    s_waitcnt lgkmcnt(0)
    v_mfma_f32_16x16x32_bf16 v[20:23], v[64:67], v[68:71], 0
    buffer_store_dwordx4 v[208:211], v1, s[64:67], s11 offen offset:0 sc1
    buffer_store_dwordx4 v[212:215], v1, s[64:67], s11 offen offset:1024 sc1
    ds_read_b128 v[72:75], v17 offset:57408
    ds_read_b128 v[76:79], v16 offset:64
    s_add_u32 s11, s11, 2048
    s_waitcnt lgkmcnt(0)
    v_mfma_f32_16x16x32_bf16 v[20:23], v[72:75], v[76:79], v[20:23]
    ds_read_b128 v[80:83], v17 offset:57472
    ds_read_b128 v[84:87], v16 offset:128
    s_waitcnt lgkmcnt(0)
    v_mfma_f32_16x16x32_bf16 v[20:23], v[80:83], v[84:87], v[20:23]
    ds_read_b128 v[88:91], v17 offset:57536
    ds_read_b128 v[92:95], v16 offset:192
    s_waitcnt lgkmcnt(0)
    v_mfma_f32_16x16x32_bf16 v[20:23], v[88:91], v[92:95], v[20:23]
    ds_read_b128 v[64:67], v17 offset:57600
    ds_read_b128 v[68:71], v16 offset:256
    s_waitcnt lgkmcnt(0)
    v_mfma_f32_16x16x32_bf16 v[20:23], v[64:67], v[68:71], v[20:23]
    ds_read_b128 v[72:75], v17 offset:57664
    ds_read_b128 v[76:79], v16 offset:320
    s_waitcnt lgkmcnt(0)
    v_mfma_f32_16x16x32_bf16 v[20:23], v[72:75], v[76:79], v[20:23]
    ds_read_b128 v[80:83], v17 offset:57728
    ds_read_b128 v[84:87], v16 offset:384
    s_waitcnt lgkmcnt(0)
    v_mfma_f32_16x16x32_bf16 v[20:23], v[80:83], v[84:87], v[20:23]
    ds_read_b128 v[88:91], v17 offset:57792
    ds_read_b128 v[92:95], v16 offset:448
    s_waitcnt lgkmcnt(0)
    v_mfma_f32_16x16x32_bf16 v[20:23], v[88:91], v[92:95], v[20:23]
    ds_read_b128 v[64:67], v17 offset:57856
    ds_read_b128 v[68:71], v16 offset:512
    s_waitcnt lgkmcnt(0)
    v_mfma_f32_16x16x32_bf16 v[20:23], v[64:67], v[68:71], v[20:23]
    ds_read_b128 v[72:75], v17 offset:57920
    ds_read_b128 v[76:79], v16 offset:576
    s_waitcnt lgkmcnt(0)
    v_mfma_f32_16x16x32_bf16 v[20:23], v[72:75], v[76:79], v[20:23]
    ds_read_b128 v[80:83], v17 offset:57984
    ds_read_b128 v[84:87], v16 offset:640
    s_waitcnt lgkmcnt(0)
    v_mfma_f32_16x16x32_bf16 v[20:23], v[80:83], v[84:87], v[20:23]
    ds_read_b128 v[88:91], v17 offset:58048
    ds_read_b128 v[92:95], v16 offset:704
    s_waitcnt lgkmcnt(0)
    v_mfma_f32_16x16x32_bf16 v[20:23], v[88:91], v[92:95], v[20:23]
    ds_read_b128 v[64:67], v17 offset:58112
    ds_read_b128 v[68:71], v16 offset:768
    s_waitcnt lgkmcnt(0)
    v_mfma_f32_16x16x32_bf16 v[20:23], v[64:67], v[68:71], v[20:23]
    ds_read_b128 v[72:75], v17 offset:58176
    ds_read_b128 v[76:79], v16 offset:832
    s_waitcnt lgkmcnt(0)
    v_mfma_f32_16x16x32_bf16 v[20:23], v[72:75], v[76:79], v[20:23]
    s_nop 7
    v_cvt_pk_bf16_f32 v20, 0, v20
    v_mul_f32 v20, 0xbfb8aa3b, v20
    v_exp_f32 v20, v20
    s_nop 0
    v_add_f32 v20, 1.0, v20
    v_rcp_f32 v20, v20
    s_nop 0
    v_cvt_pk_bf16_f32 v21, 0, v20
    v_sub_f32 v22, 1.0, v21
    v_cvt_pk_bf16_f32 v20, v21, v22
    buffer_store_dword v20, v18, s[64:67], s13 offen sc1
    buffer_store_dwordx4 v[216:219], v1, s[64:67], s11 offen offset:0 sc1
    buffer_store_dwordx4 v[220:223], v1, s[64:67], s11 offen offset:1024 sc1
    s_add_u32 s11, s11, 2048
    buffer_store_dwordx4 v[224:227], v1, s[64:67], s11 offen offset:0 sc1
    buffer_store_dwordx4 v[228:231], v1, s[64:67], s11 offen offset:1024 sc1
    s_add_u32 s11, s11, 2048
    buffer_store_dwordx4 v[232:235], v1, s[64:67], s11 offen offset:0 sc1
    buffer_store_dwordx4 v[236:239], v1, s[64:67], s11 offen offset:1024 sc1
    s_add_u32 s11, s11, 2048
    buffer_store_dwordx4 v[240:243], v1, s[64:67], s11 offen offset:0 sc1
    buffer_store_dwordx4 v[244:247], v1, s[64:67], s11 offen offset:1024 sc1
    s_add_u32 s11, s11, 2048
    s_barrier
    global_load_dword v29, v24, s[40:41]
    s_waitcnt vmcnt(1)
    s_barrier
    s_cmp_lg_u32 s3, 0
    s_cbranch_scc1 L_hnf0
    s_mov_b32 s6, 1
    s_atomic_add s6, s[46:47], 0 glc
    s_waitcnt lgkmcnt(0)
L_hw0:
    s_cmp_lg_u32 s6, 31
    s_cbranch_scc1 L_hnf0
    s_mov_b32 s10, 32
    s_atomic_add s10, s[46:47], 128
L_hnf0:
    global_load_dword v30, v26, s[40:41]
    s_endpgm
L_last:
    s_endpgm
.section .rodata,"a"
.p2align 6
.amdhsa_kernel gated_mix__ssm_conv_s4__geglu_ffn__prompt_kernel
  .amdhsa_next_free_vgpr 512
  .amdhsa_next_free_sgpr 102
  .amdhsa_accum_offset 256
  .amdhsa_group_segment_fixed_size 0
  .amdhsa_kernarg_size 136
  .amdhsa_user_sgpr_count 2
  .amdhsa_user_sgpr_kernarg_segment_ptr 1
  .amdhsa_system_sgpr_workgroup_id_x 1
.end_amdhsa_kernel
```
